```python
import torch

def _softmax(x, axis=-1):
    return torch.softmax(x, dim=axis)

def _gelu(x):
    return torch.nn.functional.gelu(x, approximate='tanh')

def _silu(x):
    return torch.nn.functional.silu(x)

def _sigmoid(x):
    return torch.sigmoid(x)

def _layernorm(x, axis=-1, eps=1e-05):
    m = x.mean(dim=axis, keepdim=True)
    v = x.var(dim=axis, keepdim=True, unbiased=False)
    return (x - m) / torch.sqrt(v + eps)

def _scatter_add(tgt, idx, src, axis=0):
    return tgt.clone().index_add_(axis, idx, src)

def _segment_sum(src, seg, n):
    out = torch.zeros((n,) + src.shape[1:], dtype=src.dtype)
    return out.index_add_(0, seg, src)

def _pad(x, pw):
    flat = tuple((v for pair in reversed(pw) for v in pair))
    return torch.nn.functional.pad(x, flat)
kernel_name = 'adaLN_cond__grouped_kv_mqa__moe_arch_mod__prompt'

def setup_inputs():

    _w = lambda a: (lambda t: t.to(torch.bfloat16) if t.is_floating_point() else t)(torch.as_tensor(a))

    def _A_setup():
        B, S, D, H = (1, 2048, 640, 32)
        Dh = D // H
        return {'x': _w((lambda *s: torch.randn(*s, dtype=torch.bfloat16) * 0.05)(B, S, D)), 'wq': _w((lambda *s: torch.randn(*s, dtype=torch.bfloat16) * 0.05)(D, H * Dh)), 'wk': _w((lambda *s: torch.randn(*s, dtype=torch.bfloat16) * 0.05)(D, Dh)), 'wv': _w((lambda *s: torch.randn(*s, dtype=torch.bfloat16) * 0.05)(D, Dh)), 'wo': _w((lambda *s: torch.randn(*s, dtype=torch.bfloat16) * 0.05)(H * Dh, D))}
    _A_in = _A_setup()

    def _B_setup():
        B, S, D, F, C = (1, 2048, 640, 1728, 1)
        return {'x': _w((lambda *s: torch.randn(*s, dtype=torch.bfloat16) * 0.05)(B, S, D)), 'w_r': _w((lambda *s: torch.randn(*s, dtype=torch.bfloat16) * 0.05)(D)), 'w_gate': _w((lambda *s: torch.randn(*s, dtype=torch.bfloat16) * 0.05)(D, F)), 'w_up': _w((lambda *s: torch.randn(*s, dtype=torch.bfloat16) * 0.05)(D, F)), 'w_down': _w((lambda *s: torch.randn(*s, dtype=torch.bfloat16) * 0.05)(F, D))}
    _B_in = _B_setup()
    return {'A_x': _A_in['x'], 'A_wq': _A_in['wq'], 'A_wk': _A_in['wk'], 'A_wv': _A_in['wv'], 'A_wo': _A_in['wo'], 'B_x': _B_in['x'], 'B_w_r': _B_in['w_r'], 'B_w_gate': _B_in['w_gate'], 'B_w_up': _B_in['w_up'], 'B_w_down': _B_in['w_down'], 'c': _w((lambda *s: torch.randn(*s, dtype=torch.bfloat16) * 0.1)(1, 640) * 8.0), 'w_mod': _w((lambda *s: torch.randn(*s, dtype=torch.bfloat16) * 0.1)(640, 6 * 640) * 640 ** (-0.5) * 8.0)}

def reference(A_x, A_wq, A_wk, A_wv, A_wo, B_x, B_w_r, B_w_gate, B_w_up, B_w_down, c, w_mod):

    def _A_ref(x, wq, wk, wv, wo):
        B, S, D = x.shape
        H = 32
        Dh = D // H
        q = (lambda x, *d: x.permute(*d))((x @ wq).reshape(B, S, H, Dh), 0, 2, 1, 3)
        k = x @ wk
        v = x @ wv
        scores = torch.einsum('bhqd,bkd->bhqk', q, k) * Dh ** (-0.5)
        p = _softmax(scores, axis=-1)
        o = torch.einsum('bhqk,bkd->bhqd', p, v)
        return (lambda x, *d: x.permute(*d))(o, 0, 2, 1, 3).reshape(B, S, H * Dh) @ wo

    def _B_ref(x, w_r, w_gate, w_up, w_down):
        B, S, D = x.shape
        C = 1
        r = x @ w_r
        idx = torch.argsort(-r, axis=-1)[:, :C]
        idx_e = (lambda x, n, axis: torch.repeat_interleave(x, n, dim=axis))(idx.reshape(B, C, 1), D, axis=2)
        x_sel = (lambda x, i, axis: torch.take_along_dim(x, i, dim=axis))(x, idx_e, axis=1)
        g = _silu(x_sel @ w_gate)
        u = x_sel @ w_up
        y = g * u @ w_down
        r_sel = _sigmoid((lambda x, i, axis: torch.take_along_dim(x, i, dim=axis))(r, idx, axis=1))
        y = y * r_sel.reshape(B, C, 1)
        b_off = (torch.arange(B) * S).reshape(B, 1)
        flat_idx = (idx + b_off).reshape(B * C)
        zero = (x * 0.0).reshape(B * S, D)
        upd = _scatter_add(zero, flat_idx, y.reshape(B * C, D), axis=0)
        return x + upd.reshape(B, S, D)
    x = A_x
    mod = (_silu(c) @ w_mod).reshape(c.shape[0], 6, 1, -1)
    sa, ca, ga, sb, cb, gb = (mod[:, 0].clone(), mod[:, 1].clone(), mod[:, 2].clone(), mod[:, 3].clone(), mod[:, 4].clone(), mod[:, 5].clone())
    h = _layernorm(x, axis=-1) * (1 + ca) + sa
    x = x + ga * _A_ref(h, A_wq, A_wk, A_wv, A_wo)
    h = _layernorm(x, axis=-1) * (1 + cb) + sb
    x = x + gb * _B_ref(h, B_w_r, B_w_gate, B_w_up, B_w_down)
    return x
```

```asm
; @launch grid=(256,1,1) block=(512,1,1) lds=163840
.amdgcn_target "amdgcn-amd-amdhsa--gfx950"
.text
.globl adaLN_cond__grouped_kv_mqa__moe_arch_mod__prompt_kernel
.p2align 8
.type adaLN_cond__grouped_kv_mqa__moe_arch_mod__prompt_kernel,@function
adaLN_cond__grouped_kv_mqa__moe_arch_mod__prompt_kernel:
    s_load_dwordx2 s[24:25], s[0:1], 88
    s_load_dwordx2 s[28:29], s[0:1], 80
    s_load_dwordx2 s[8:9], s[0:1], 0
    s_load_dwordx2 s[32:33], s[0:1], 112
    s_cmp_ge_u32 s2, 256
    s_cbranch_scc1 L_end
    s_getpc_b64 s[50:51]
L_pc0:
    v_lshrrev_b32 v2, 6, v0
    s_and_b32 s52, s2, 0xf8
    v_add_u32 v3, s52, v2
    v_and_b32 v1, 63, v0
    v_readfirstlane_b32 s3, v2
    v_lshlrev_b32 v3, 7, v3
    v_min_u32 v3, L_end-L_pc0, v3
    global_load_dword v15, v3, s[50:51]
    s_mov_b32 s27, 0x20000
    s_mov_b32 s26, 4915200
    s_mov_b32 s31, s27
    s_movk_i32 s30, 1280
    s_and_b32 s52, s2, 3
    s_lshr_b32 s50, s2, 4
    s_lshl_b32 s50, s50, 2
    s_bfe_u32 s51, s2, 0x10002
    s_lshl_b32 s51, s51, 1
    s_add_u32 s50, s50, s51
    s_bfe_u32 s51, s2, 0x10003
    s_add_u32 s50, s50, s51
    s_mul_i32 s58, s52, 1228800
    s_lshl_b32 s51, s50, 6
    s_add_u32 s58, s58, s51
    v_lshrrev_b32 v10, 2, v1
    v_mul_u32_u24 v12, 76800, v10
    v_and_b32 v13, 3, v1
    v_lshl_add_u32 v12, v13, 4, v12
    v_mul_u32_u24 v10, 20, v10
    s_mul_i32 s53, s52, 320
    s_and_b32 s4, s2, 31
    s_lshr_b32 s5, s2, 5
    s_lshl_b32 s51, s4, 3
    s_add_u32 s51, s51, s5
    s_lshl_b32 s51, s51, 3
    s_add_u32 s51, s51, s3
    s_mul_i32 s51, s51, 1280
    v_lshl_add_u32 v20, v1, 4, s51
    v_lshl_add_u32 v18, v1, 2, s51
    v_mov_b32 v17, 0
    s_mul_i32 s51, s3, 160
    s_add_u32 s51, s51, s2
    s_cmp_lt_u32 s51, 160
    s_waitcnt lgkmcnt(0)
    global_load_dword v63, v17, s[32:33] sc1
    s_cbranch_scc0 L_nomod
    s_setprio 3
    buffer_load_dwordx4 v[208:211], v10, s[28:31], s53 offen
    buffer_load_dword v212, v10, s[28:31], s53 offen offset:16
    buffer_load_dwordx4 v[216:219], v12, s[24:27], s58 offen nt
    s_addk_i32 s58, 7680
    buffer_load_dwordx4 v[220:223], v12, s[24:27], s58 offen nt
    s_addk_i32 s58, 7680
    buffer_load_dwordx4 v[224:227], v12, s[24:27], s58 offen nt
    s_addk_i32 s58, 7680
    buffer_load_dwordx4 v[228:231], v12, s[24:27], s58 offen nt
    s_addk_i32 s58, 7680
    buffer_load_dwordx4 v[232:235], v12, s[24:27], s58 offen nt
    s_addk_i32 s58, 7680
    buffer_load_dwordx4 v[236:239], v12, s[24:27], s58 offen nt
    s_addk_i32 s58, 7680
    buffer_load_dwordx4 v[240:243], v12, s[24:27], s58 offen nt
    s_addk_i32 s58, 7680
    buffer_load_dwordx4 v[244:247], v12, s[24:27], s58 offen nt
    s_addk_i32 s58, 7680
    buffer_load_dwordx4 v[248:251], v12, s[24:27], s58 offen nt
    s_addk_i32 s58, 7680
    buffer_load_dwordx4 v[252:255], v12, s[24:27], s58 offen nt
    s_mul_i32 s59, s52, 15360
    s_lshl_b32 s50, s50, 7
    s_add_u32 s59, s59, s50
    s_add_u32 s59, s59, 4096
    v_mov_b32 v17, s59
    global_load_dword v15, v17, s[32:33] sc1
L_nomod:
    s_load_dwordx2 s[12:13], s[0:1], 8
    s_load_dwordx2 s[16:17], s[0:1], 16
    s_load_dwordx2 s[96:97], s[0:1], 24
    s_mov_b32 s35, s27
    s_mov_b32 s11, s27
    s_mov_b32 s15, s27
    s_mov_b32 s19, s27
    s_mov_b32 s99, s27
    s_mov_b32 s34, 8388608
    s_mov_b32 s10, 2621440
    s_mov_b32 s14, 819200
    s_movk_i32 s18, 25600
    s_movk_i32 s98, 25600
    s_and_b32 s6, s3, 3
    s_lshr_b32 s7, s3, 2
    v_lshlrev_b32 v4, 4, v1
    v_lshrrev_b32 v3, 4, v1
    s_cmp_ge_u32 s3, 6
    s_cbranch_scc0 L_skip_4
    s_setprio 1
    v_lshlrev_b32 v10, 7, v1
    s_lshl_b32 s50, s2, 1
    s_and_b32 s51, s3, 1
    s_add_u32 s50, s50, s51
    s_mul_i32 s50, s50, 1600
    s_andn2_b32 s50, s50, 127
    s_lshr_b32 s52, s2, 3
    s_lshl_b32 s52, s52, 1
    s_add_u32 s52, s52, s51
    s_mul_i32 s52, s52, 400
    s_andn2_b32 s52, s52, 127
    s_waitcnt lgkmcnt(0)
    s_mov_b64 exec, 0x1fff
    buffer_load_dword v15, v10, s[12:15], s50 offen
    s_mov_b64 exec, 0xf
    buffer_load_dword v15, v10, s[16:19], s52 offen
    buffer_load_dword v15, v10, s[96:99], s52 offen
    s_mov_b64 exec, -1
L_skip_4:
    s_waitcnt lgkmcnt(0)
    s_load_dwordx2 s[20:21], s[0:1], 32
    s_load_dwordx2 s[40:41], s[0:1], 48
    s_load_dwordx2 s[36:37], s[0:1], 96
    s_load_dwordx2 s[86:87], s[0:1], 56
    s_load_dwordx2 s[88:89], s[0:1], 64
    s_load_dwordx2 s[94:95], s[0:1], 72
    v_and_b32 v2, 15, v1
    v_lshlrev_b32 v5, 3, v1
    v_mov_b32 v7, 0xdddddddd
    s_lshl_b32 s50, s3, 6
    v_add_u32 v64, s50, v1
    s_mul_i32 s90, s5, 160
    v_mul_u32_u24 v65, 6554, v64
    v_lshrrev_b32 v65, 16, v65
    v_mul_u32_u24 v66, 10, v65
    v_sub_u32 v66, v64, v66
    v_mul_u32_u24 v65, 1280, v65
    v_lshl_add_u32 v168, v66, 4, v65
    v_add_u32 v64, 512, v64
    v_mul_u32_u24 v65, 6554, v64
    v_lshrrev_b32 v65, 16, v65
    v_mul_u32_u24 v66, 10, v65
    v_sub_u32 v66, v64, v66
    v_mul_u32_u24 v65, 1280, v65
    v_lshl_add_u32 v169, v66, 4, v65
    v_add_u32 v64, 512, v64
    v_mul_u32_u24 v65, 6554, v64
    v_lshrrev_b32 v65, 16, v65
    v_mul_u32_u24 v66, 10, v65
    v_sub_u32 v66, v64, v66
    v_mul_u32_u24 v65, 1280, v65
    v_lshl_add_u32 v170, v66, 4, v65
    v_add_u32 v64, 512, v64
    v_mul_u32_u24 v65, 6554, v64
    v_lshrrev_b32 v65, 16, v65
    v_mul_u32_u24 v66, 10, v65
    v_sub_u32 v66, v64, v66
    v_mul_u32_u24 v65, 1280, v65
    v_lshl_add_u32 v171, v66, 4, v65
    v_add_u32 v64, 512, v64
    v_mul_u32_u24 v65, 6554, v64
    v_lshrrev_b32 v65, 16, v65
    v_mul_u32_u24 v66, 10, v65
    v_sub_u32 v66, v64, v66
    v_mul_u32_u24 v65, 1280, v65
    v_lshl_add_u32 v172, v66, 4, v65
    v_and_b32 v64, 31, v1
    v_lshrrev_b32 v65, 5, v1
    v_mul_u32_u24 v66, 20, v65
    v_add_u32 v66, v66, v64
    v_cmp_lt_u32 vcc, 19, v64
    v_subrev_u32 v67, 2, v66
    v_mov_b32 v68, 40
    v_cndmask_b32 v66, v66, v67, vcc
    v_and_b32 v67, 27, v64
    v_cmp_eq_u32 vcc, 18, v67
    v_mov_b32 v69, 133169152
    s_mov_b32 s50, 0xff880000
    v_cndmask_b32 v66, v66, v68, vcc
    s_mov_b32 s51, 0xff880000
    s_nop 0
    v_cndmask_b32 v66, v66, v69, s[50:51]
    v_lshlrev_b32 v6, 4, v66
    global_load_dwordx4 v[104:107], v20, s[8:9]
    global_load_dword v108, v18, s[8:9] offset:1024
    s_mul_i32 s50, s6, 49152
    s_add_u32 s50, s50, 655360
    s_bfe_u32 s51, s2, 196611
    s_mul_i32 s60, s51, 6144
    s_add_u32 s60, s60, s50
    s_add_u32 s61, s60, 3072
    s_add_u32 s51, s51, 1
    s_and_b32 s51, s51, 7
    s_mul_i32 s62, s51, 6144
    s_add_u32 s62, s62, s50
    s_add_u32 s63, s62, 3072
    s_add_u32 s51, s51, 1
    s_and_b32 s51, s51, 7
    s_mul_i32 s64, s51, 6144
    s_add_u32 s64, s64, s50
    s_add_u32 s65, s64, 3072
    s_add_u32 s51, s51, 1
    s_and_b32 s51, s51, 7
    s_mul_i32 s66, s51, 6144
    s_add_u32 s66, s66, s50
    s_add_u32 s67, s66, 3072
    s_add_u32 s51, s51, 1
    s_and_b32 s51, s51, 7
    s_mul_i32 s68, s51, 6144
    s_add_u32 s68, s68, s50
    s_add_u32 s69, s68, 3072
    s_add_u32 s51, s51, 1
    s_and_b32 s51, s51, 7
    s_mul_i32 s70, s51, 6144
    s_add_u32 s70, s70, s50
    s_add_u32 s71, s70, 3072
    s_add_u32 s51, s51, 1
    s_and_b32 s51, s51, 7
    s_mul_i32 s72, s51, 6144
    s_add_u32 s72, s72, s50
    s_add_u32 s73, s72, 3072
    s_add_u32 s51, s51, 1
    s_and_b32 s51, s51, 7
    s_mul_i32 s74, s51, 6144
    s_add_u32 s74, s74, s50
    s_add_u32 s75, s74, 3072
    v_and_b32 v64, 7, v1
    v_bfe_u32 v66, v1, 3, 2
    v_lshlrev_b32 v67, 4, v64
    v_lshl_add_u32 v67, v65, 10, v67
    v_lshl_add_u32 v175, v66, 2, v67
    v_add_u32 v175, 8192, v175
    v_lshl_add_u32 v174, v66, 11, v67
    v_mul_u32_u24 v64, 208, v64
    v_mul_u32_u24 v66, 48, v66
    v_lshlrev_b32 v67, 4, v65
    v_add3_u32 v64, v64, v66, v67
    s_and_b32 s50, s3, 4
    s_add_u32 s51, s3, 0
    s_and_b32 s51, s51, 3
    s_or_b32 s51, s51, s50
    s_mul_i32 s51, s51, 1664
    s_add_u32 s51, s51, 143360
    v_add_u32 v28, s51, v64
    s_add_u32 s51, s3, 1
    s_and_b32 s51, s51, 3
    s_or_b32 s51, s51, s50
    s_mul_i32 s51, s51, 1664
    s_add_u32 s51, s51, 143360
    v_add_u32 v29, s51, v64
    s_add_u32 s51, s3, 2
    s_and_b32 s51, s51, 3
    s_or_b32 s51, s51, s50
    s_mul_i32 s51, s51, 1664
    s_add_u32 s51, s51, 143360
    v_add_u32 v30, s51, v64
    s_add_u32 s51, s3, 3
    s_and_b32 s51, s51, 3
    s_or_b32 s51, s51, s50
    s_mul_i32 s51, s51, 1664
    s_add_u32 s51, s51, 143360
    v_add_u32 v31, s51, v64
    v_cmp_lt_u32 vcc, 31, v1
    v_bfe_u32 v68, v1, 2, 2
    v_bfe_u32 v69, v1, 4, 1
    v_cndmask_b32 v32, v28, v29, vcc
    v_cndmask_b32 v33, v30, v31, vcc
    v_sub_u32 v32, v32, v67
    v_sub_u32 v33, v33, v67
    v_lshl_add_u32 v70, v69, 2, v68
    v_mul_u32_u24 v71, 20, v65
    v_add_u32 v71, v71, v70
    v_lshrrev_b32 v72, 1, v68
    v_mul_u32_u24 v72, 20, v72
    v_and_b32 v73, 1, v68
    v_lshl_add_u32 v72, v69, 1, v72
    v_add3_u32 v72, v72, v73, 16
    v_and_b32 v73, 3, v1
    v_mul_u32_u24 v74, 40, v73
    s_lshl_b32 s50, s7, 1
    s_and_b32 s51, s3, 1
    s_add_u32 s50, s50, s51
    s_mul_i32 s50, s50, 25600
    v_mul_u32_u24 v71, 160, v71
    v_mul_u32_u24 v72, 160, v72
    v_add3_u32 v56, v71, v74, s50
    v_add3_u32 v72, v72, v74, s50
    v_add_u32 v75, 9600, v56
    v_add_u32 v76, 10880, v56
    v_add_u32 v77, 6400, v72
    v_cndmask_b32 v57, v72, v75, vcc
    v_cndmask_b32 v58, v77, v76, vcc
    v_add_u32 v75, 22400, v56
    v_add_u32 v76, 23680, v56
    v_add_u32 v77, 12800, v72
    v_add_u32 v72, 19200, v72
    v_cndmask_b32 v59, v75, v77, vcc
    v_cndmask_b32 v60, v76, v72, vcc
    v_lshlrev_b32 v75, 4, v2
    v_lshl_add_u32 v61, v3, 10, v75
    v_mul_u32_u24 v75, 1280, v2
    v_mul_u32_u24 v76, 40, v3
    v_add_u32 v62, v75, v76
    s_sub_u32 s50, s2, 16
    s_and_b32 s51, s50, 3
    s_lshr_b32 s50, s50, 2
    s_min_u32 s50, s50, 59
    s_mul_i32 s84, s51, 15360
    s_lshl_b32 s52, s50, 8
    s_add_u32 s84, s84, s52
    s_add_u32 s84, s84, 4096
    s_mul_i32 s51, s51, 20
    s_add_u32 s51, s51, s3
    s_mul_i32 s83, s51, 61440
    s_lshl_b32 s52, s50, 7
    s_add_u32 s83, s83, s52
    s_lshl_b32 s51, s51, 4
    v_lshrrev_b32 v13, 3, v1
    v_lshlrev_b32 v14, 1, v13
    v_mul_u32_u24 v13, 7680, v13
    v_and_b32 v16, 7, v1
    v_lshl_add_u32 v55, v16, 4, v13
    buffer_load_ushort v52, v14, s[28:31], s51 offen offset:0
    buffer_load_ushort v53, v14, s[28:31], s51 offen offset:128
    buffer_load_ushort v54, v14, s[28:31], s51 offen offset:256
    v_lshl_add_u32 v70, v3, 3, v70
    s_and_b32 s50, s3, 1
    s_lshl_b32 s50, s50, 1
    s_add_u32 s50, s50, s7
    s_mul_i32 s50, s50, 5120
    v_mul_u32_u24 v71, 160, v70
    v_add3_u32 v46, v71, v74, s50
    v_xor_b32 v70, 4, v70
    v_mul_u32_u24 v71, 160, v70
    v_add3_u32 v47, v71, v74, s50
    v_add_u32 v48, 61440, v46
    v_add_u32 v49, 61440, v47
    v_and_b32 v71, 7, v1
    v_lshlrev_b32 v71, 2, v71
    v_lshl_add_u32 v71, v3, 5, v71
    v_and_b32 v72, 8, v1
    v_lshl_add_u32 v50, v72, 6, v71
    s_mul_i32 s50, s6, 3328
    s_add_u32 s50, s50, 143360
    v_mul_u32_u24 v71, 208, v2
    v_mul_u32_u24 v72, 48, v3
    v_add3_u32 v51, v71, v72, s50
    s_cmp_ge_u32 s2, 96
    s_cselect_b32 s79, -1, 1
    s_waitcnt lgkmcnt(0)
    s_mov_b32 s22, 819200
    s_mov_b32 s23, 0x20000
    s_mov_b32 s38, 2621440
    s_mov_b32 s39, 0x20000
    s_mov_b32 s42, 1280
    s_mov_b32 s43, 0x20000
    s_mov_b32 s46, 2211840
    s_mov_b32 s47, 0x20000
    s_and_b32 s50, s2, 7
    s_lshr_b32 s51, s2, 3
    s_cmp_lt_u32 s2, 216
    s_cbranch_scc0 L_f2_5
    s_mul_i32 s78, s50, 27
    s_add_u32 s78, s78, s51
    s_cmp_lt_u32 s3, 4
    s_cselect_b32 s44, s86, s88
    s_cselect_b32 s45, s87, s89
    s_mul_i32 s76, s6, 552960
    s_lshl_b32 s50, s78, 4
    s_add_u32 s76, s76, s50
    s_mov_b32 s77, 110592
    s_add_u32 s92, s76, 442368
    s_mov_b32 s93, 0xffff
    v_lshl_add_u32 v64, v65, 4, v2
    v_mul_u32_u24 v173, 3456, v64
    s_branch L_fset_6
L_f2_5:
    s_mul_i32 s78, s50, 5
    s_sub_u32 s51, s51, 27
    s_add_u32 s78, s78, s51
    s_mov_b32 s44, s94
    s_mov_b32 s45, s95
    s_mul_i32 s76, s3, 286720
    s_lshl_b32 s50, s78, 5
    s_add_u32 s76, s76, s50
    s_mov_b32 s77, 40960
    s_add_u32 s92, s50, 2170880
    s_mov_b32 s93, -1
    v_lshrrev_b32 v64, 1, v1
    v_mul_u32_u24 v64, 1280, v64
    v_and_b32 v65, 1, v1
    v_lshl_add_u32 v173, v65, 4, v64
L_fset_6:
    s_bitcmp0_b32 s3, 0
    s_cselect_b32 s28, s86, s88
    s_cselect_b32 s29, s87, s89
    s_mov_b32 s30, s46
    s_mul_i32 s50, s4, 81920
    s_add_u32 s50, s50, 1048576
    s_mul_i32 s80, s5, 10240
    s_lshl_b32 s51, s3, 7
    s_add_u32 s80, s80, s51
    s_add_u32 s80, s80, s50
    s_lshl_b32 s81, s7, 1
    s_and_b32 s51, s3, 1
    s_add_u32 s81, s81, s51
    s_mul_i32 s81, s81, 20480
    s_lshl_b32 s51, s6, 8
    s_add_u32 s81, s81, s51
    s_add_u32 s81, s81, s50
    s_lshl_b32 s50, s4, 2
    s_add_u32 s50, s50, s6
    s_mul_i32 s82, s50, 20480
    s_add_u32 s82, s82, s90
    s_cmp_ge_u32 s3, 1
    s_cbranch_scc0 L_w0_8
    s_cmp_lt_u32 s3, 6
    s_cbranch_scc0 L_dma2_9
    s_sub_u32 s58, s3, 1
    s_mul_i32 s50, s58, 5120
    s_mul_i32 s59, s58, 10240
    s_add_u32 s59, s59, 102400
    s_lshl_b32 s52, s4, 3
    s_add_u32 s52, s52, s5
    s_mul_i32 s52, s52, 10240
    s_lshl_b32 s51, s58, 8
    s_add_u32 s52, s52, s51
    v_lshrrev_b32 v12, 3, v1
    v_and_b32 v11, 7, v1
    v_mul_u32_u24 v10, 1280, v12
    v_lshl_add_u32 v10, v11, 4, v10
    v_lshlrev_b32 v12, 2, v12
    v_lshl_add_u32 v119, v11, 5, v12
    s_add_u32 s51, s50, 4096
    buffer_load_dwordx4 v[88:91], v10, s[8:11], s52 offen offset:0
    buffer_load_dwordx4 v[92:95], v10, s[8:11], s52 offen offset:128
    s_add_u32 m0, s59, 0
    s_nop 0
    buffer_load_dwordx4 v4, s[16:19], s50 offen offset:0  lds
    buffer_load_dwordx4 v4, s[16:19], s50 offen offset:1024  lds
    buffer_load_dwordx4 v4, s[16:19], s50 offen offset:2048  lds
    buffer_load_dwordx4 v4, s[16:19], s50 offen offset:3072  lds
    s_add_u32 m0, s59, 4096
    s_nop 0
    buffer_load_dwordx4 v4, s[16:19], s51 offen  lds
    s_add_u32 m0, s59, 5120
    s_nop 0
    buffer_load_dwordx4 v4, s[96:99], s50 offen offset:0  lds
    buffer_load_dwordx4 v4, s[96:99], s50 offen offset:1024  lds
    buffer_load_dwordx4 v4, s[96:99], s50 offen offset:2048  lds
    buffer_load_dwordx4 v4, s[96:99], s50 offen offset:3072  lds
    s_add_u32 m0, s59, 9216
    s_nop 0
    buffer_load_dwordx4 v4, s[96:99], s51 offen  lds
    v_bfe_u32 v80, v1, 2, 2
    v_bfe_u32 v81, v1, 4, 1
    v_lshl_add_u32 v80, v81, 2, v80
    v_lshl_add_u32 v80, v3, 3, v80
    v_xor_b32 v81, 4, v80
    v_mul_u32_u24 v80, 40, v80
    v_mul_u32_u24 v81, 40, v81
    v_and_b32 v82, 3, v1
    v_lshlrev_b32 v83, 3, v82
    v_and_b32 v82, 1, v1
    v_mul_u32_u24 v82, 5120, v82
    v_add3_u32 v84, v80, v83, s59
    v_add3_u32 v85, v81, v83, s59
    v_add3_u32 v86, v80, v82, s59
    v_add3_u32 v87, v81, v82, s59
    v_and_b32 v80, 31, v1
    v_lshrrev_b32 v81, 5, v1
    v_mul_u32_u24 v82, 2560, v81
    v_lshl_add_u32 v120, v80, 4, v82
    v_add_u32 v121, s59, v4
    v_cvt_f32_u32 v25, v81
    v_lshrrev_b32 v80, 3, v1
    v_and_b32 v81, 7, v1
    v_and_b32 v82, 1, v80
    v_lshlrev_b32 v82, 4, v82
    v_lshl_add_u32 v82, v80, 5, v82
    v_add_u32 v122, s59, v82
    v_xor_b32 v123, 16, v122
    v_lshlrev_b32 v81, 4, v81
    v_lshl_add_u32 v24, v80, 10, v81
    v_lshlrev_b32 v82, 7, v3
    v_add3_u32 v125, v82, v81, s59
    s_lshl_b32 s50, s58, 9
    s_add_u32 s50, s50, 160000
    v_lshl_add_u32 v124, v1, 2, s50
    s_mul_i32 s50, s58, 1280
    s_add_u32 s50, s50, 153600
    v_mul_u32_u24 v80, 80, v2
    v_lshlrev_b32 v81, 4, v3
    v_add3_u32 v126, v80, v81, s50
    v_lshlrev_b32 v80, 5, v2
    v_add3_u32 v127, v80, v81, s50
    s_lshl_b32 s50, s58, 9
    s_add_u32 s54, s50, 4096
    s_add_u32 s55, s54, 15360
    s_add_u32 s56, s55, 15360
    s_add_u32 s57, s56, 15360
    s_mul_i32 s50, s4, 81920
    s_lshl_b32 s51, s58, 14
    s_add_u32 s50, s50, s51
    s_lshl_b32 s51, s5, 7
    s_add_u32 s50, s50, s51
    s_add_u32 s50, s50, 4718592
    s_add_u32 s51, s50, 8192
    v_and_b32 v80, 7, v1
    v_lshlrev_b32 v80, 3, v80
    v_add_u32 v80, 162816, v80
    s_waitcnt vmcnt(12)
    s_mov_b32 s52, 0x3f803f80
    v_dot2_f32_bf16 v110, v104, s52, 0
    v_dot2_f32_bf16 v111, v104, v104, 0
    v_dot2_f32_bf16 v110, v105, s52, v110
    v_dot2_f32_bf16 v111, v105, v105, v111
    v_dot2_f32_bf16 v110, v106, s52, v110
    v_dot2_f32_bf16 v111, v106, v106, v111
    v_dot2_f32_bf16 v110, v107, s52, v110
    v_dot2_f32_bf16 v111, v107, v107, v111
    v_dot2_f32_bf16 v110, v108, s52, v110
    v_dot2_f32_bf16 v111, v108, v108, v111
    s_nop 2
    v_add_f32_dpp v110, v110, v110 row_ror:8 row_mask:0xf bank_mask:0xf
    v_add_f32_dpp v111, v111, v111 row_ror:8 row_mask:0xf bank_mask:0xf
    s_nop 0
    v_add_f32_dpp v110, v110, v110 row_ror:4 row_mask:0xf bank_mask:0xf
    v_add_f32_dpp v111, v111, v111 row_ror:4 row_mask:0xf bank_mask:0xf
    s_nop 0
    v_add_f32_dpp v110, v110, v110 row_ror:2 row_mask:0xf bank_mask:0xf
    v_add_f32_dpp v111, v111, v111 row_ror:2 row_mask:0xf bank_mask:0xf
    s_nop 0
    v_add_f32_dpp v110, v110, v110 row_ror:1 row_mask:0xf bank_mask:0xf
    v_add_f32_dpp v111, v111, v111 row_ror:1 row_mask:0xf bank_mask:0xf
    s_nop 0
    v_mov_b32 v104, v110
    v_mov_b32 v105, v111
    s_nop 1
    v_permlane32_swap_b32 v110, v104
    v_permlane32_swap_b32 v111, v105
    v_add_f32 v110, v110, v104
    v_add_f32 v111, v111, v105
    v_mov_b32 v104, v110
    v_mov_b32 v105, v111
    s_nop 1
    v_permlane16_swap_b32 v110, v104
    v_permlane16_swap_b32 v111, v105
    v_add_f32 v110, v110, v104
    v_add_f32 v111, v111, v105
    v_mul_f32 v110, 0x3acccccd, v110
    v_mul_f32 v111, 0x3acccccd, v111
    v_fma_f32 v111, -v110, v110, v111
    v_max_f32 v111, 0, v111
    v_add_f32 v111, 0x3727c5ac, v111
    v_rsq_f32 v111, v111
    s_lshl_b32 s52, s3, 3
    s_add_u32 s52, s52, 162816
    v_mul_f32 v110, v110, v111
    v_mov_b32 v109, s52
    s_mov_b64 exec, 1
    ds_write_b64 v109, v[110:111]
    s_mov_b64 exec, -1
    v_readfirstlane_b32 s48, v63
    s_getreg_b32 s91, hwreg(HW_REG_XCC_ID, 0, 4)
    s_nop 2
    s_add_u32 s48, s48, 0x01010101
    s_xor_b32 s91, s91, s48
    s_and_b32 s86, s48, 0xff
    s_bfe_u32 s87, s48, 0x80008
    s_bfe_u32 s88, s48, 0x80010
    s_lshr_b32 s89, s48, 24
    s_bitcmp1_b32 14, s3
    s_cbranch_scc0 L_skip_10
    s_waitcnt vmcnt(0)
    s_mov_b32 s58, 0xff00ff00
    s_mov_b32 s59, 0xff00ff00
    ds_bpermute_b32 v88, v119, v88
    ds_bpermute_b32 v89, v119, v89
    ds_bpermute_b32 v90, v119, v90
    ds_bpermute_b32 v91, v119, v91
    ds_bpermute_b32 v92, v119, v92
    ds_bpermute_b32 v93, v119, v93
    ds_bpermute_b32 v94, v119, v94
    ds_bpermute_b32 v95, v119, v95
    ds_read_b64_tr_b16 v[208:209], v84 offset:0
    ds_read_b64_tr_b16 v[210:211], v85 offset:0
    ds_read_b64_tr_b16 v[212:213], v84 offset:5120
    ds_read_b64_tr_b16 v[214:215], v85 offset:5120
    ds_read_b64_tr_b16 v[216:217], v86 offset:32
    ds_read_b64_tr_b16 v[218:219], v87 offset:32
    s_waitcnt lgkmcnt(13)
    ds_read_b64_tr_b16 v[220:221], v84 offset:1280
    ds_read_b64_tr_b16 v[222:223], v85 offset:1280
    s_waitcnt lgkmcnt(13)
    ds_read_b64_tr_b16 v[224:225], v84 offset:6400
    ds_read_b64_tr_b16 v[226:227], v85 offset:6400
    s_waitcnt lgkmcnt(13)
    ds_read_b64_tr_b16 v[228:229], v86 offset:1312
    ds_read_b64_tr_b16 v[230:231], v87 offset:1312
    s_waitcnt lgkmcnt(13)
    ds_read_b64_tr_b16 v[232:233], v84 offset:2560
    ds_read_b64_tr_b16 v[234:235], v85 offset:2560
    s_waitcnt lgkmcnt(13)
    ds_read_b64_tr_b16 v[236:237], v84 offset:7680
    ds_read_b64_tr_b16 v[238:239], v85 offset:7680
    s_waitcnt lgkmcnt(13)
    ds_read_b64_tr_b16 v[240:241], v86 offset:2592
    ds_read_b64_tr_b16 v[242:243], v87 offset:2592
    s_waitcnt lgkmcnt(13)
    ds_read_b64_tr_b16 v[244:245], v84 offset:3840
    ds_read_b64_tr_b16 v[246:247], v85 offset:3840
    s_waitcnt lgkmcnt(13)
    ds_read_b64_tr_b16 v[248:249], v84 offset:8960
    ds_read_b64_tr_b16 v[250:251], v85 offset:8960
    s_waitcnt lgkmcnt(13)
    ds_read_b64_tr_b16 v[252:253], v86 offset:3872
    ds_read_b64_tr_b16 v[254:255], v87 offset:3872
    v_cndmask_b32 v96, v88, v90, s[58:59]
    v_cndmask_b32 v97, v89, v91, s[58:59]
    v_cndmask_b32 v98, v90, v88, s[58:59]
    v_cndmask_b32 v99, v91, v89, s[58:59]
    v_cndmask_b32 v100, v92, v94, s[58:59]
    v_cndmask_b32 v101, v93, v95, s[58:59]
    v_cndmask_b32 v102, v94, v92, s[58:59]
    v_cndmask_b32 v103, v95, v93, s[58:59]
    v_lshlrev_b32 v64, 16, v96
    v_and_b32 v65, 0xffff0000, v96
    v_lshlrev_b32 v66, 16, v97
    v_and_b32 v67, 0xffff0000, v97
    v_lshlrev_b32 v68, 16, v98
    v_and_b32 v69, 0xffff0000, v98
    v_lshlrev_b32 v70, 16, v99
    v_and_b32 v71, 0xffff0000, v99
    v_lshlrev_b32 v72, 16, v100
    v_and_b32 v73, 0xffff0000, v100
    v_lshlrev_b32 v74, 16, v101
    v_and_b32 v75, 0xffff0000, v101
    v_lshlrev_b32 v76, 16, v102
    v_and_b32 v77, 0xffff0000, v102
    v_lshlrev_b32 v78, 16, v103
    v_and_b32 v79, 0xffff0000, v103
    v_lshlrev_b32 v52, 16, v52
    v_lshlrev_b32 v53, 16, v53
    v_lshlrev_b32 v54, 16, v54
    v_mul_f32 v96, 0xbfb8aa3b, v52
    v_mul_f32 v97, 0xbfb8aa3b, v53
    v_mul_f32 v98, 0xbfb8aa3b, v54
    v_exp_f32 v96, v96
    v_exp_f32 v97, v97
    v_exp_f32 v98, v98
    v_add_f32 v96, 1.0, v96
    v_add_f32 v97, 1.0, v97
    v_add_f32 v98, 1.0, v98
    v_rcp_f32 v96, v96
    v_rcp_f32 v97, v97
    v_rcp_f32 v98, v98
    v_mul_f32 v96, v96, v52
    v_mul_f32 v97, v97, v53
    v_mul_f32 v98, v98, v54
    v_and_b32 v99, 1, v1
    v_lshlrev_b32 v99, 4, v99
    s_sub_u32 s52, s7, 1
    v_cvt_pk_bf16_f32 v96, v96, 0
    v_cvt_pk_bf16_f32 v97, v97, 0
    v_cvt_pk_bf16_f32 v98, v98, 0
    v_lshlrev_b32 v96, v99, v96
    v_lshlrev_b32 v97, v99, v97
    v_lshlrev_b32 v98, v99, v98
    v_and_b32 v98, s52, v98
    v_bfe_u32 v99, v1, 1, 2
    v_xor_b32 v52, 0, v99
    v_subrev_u32 v52, 1, v52
    v_ashrrev_i32 v52, 31, v52
    v_and_b32 v34, v52, v96
    v_and_b32 v38, v52, v97
    v_and_b32 v42, v52, v98
    v_xor_b32 v52, 1, v99
    v_subrev_u32 v52, 1, v52
    v_ashrrev_i32 v52, 31, v52
    v_and_b32 v35, v52, v96
    v_and_b32 v39, v52, v97
    v_and_b32 v43, v52, v98
    v_xor_b32 v52, 2, v99
    v_subrev_u32 v52, 1, v52
    v_ashrrev_i32 v52, 31, v52
    v_and_b32 v36, v52, v96
    v_and_b32 v40, v52, v97
    v_and_b32 v44, v52, v98
    v_xor_b32 v52, 3, v99
    v_subrev_u32 v52, 1, v52
    v_ashrrev_i32 v52, 31, v52
    v_and_b32 v37, v52, v96
    v_and_b32 v41, v52, v97
    v_and_b32 v45, v52, v98
    v_and_b32 v52, 7, v1
    v_lshlrev_b32 v52, 5, v52
    v_and_b32 v53, 1, v3
    v_lshl_add_u32 v52, v53, 4, v52
    v_lshrrev_b32 v53, 5, v1
    v_lshl_add_u32 v52, v53, 8, v52
    s_lshl_b32 s52, s3, 9
    s_add_u32 s52, s52, 106496
    v_add_u32 v54, s52, v52
L_skip_10:
    s_setprio 2
    s_waitcnt lgkmcnt(0)
    s_barrier
    ds_read_b64 v[82:83], v80
    buffer_load_dwordx4 v[8:11], v120, s[32:35], s54 offen sc1
    buffer_load_dwordx4 v[12:15], v120, s[32:35], s55 offen sc1
    buffer_load_dwordx4 v[16:19], v120, s[32:35], s56 offen sc1
    buffer_load_dwordx4 v[20:23], v120, s[32:35], s57 offen sc1
    s_bitcmp1_b32 48, s3
    s_cbranch_scc0 L_skip_11
    s_waitcnt vmcnt(4)
    s_mov_b32 s58, 0xff00ff00
    s_mov_b32 s59, 0xff00ff00
    ds_bpermute_b32 v88, v119, v88
    ds_bpermute_b32 v89, v119, v89
    ds_bpermute_b32 v90, v119, v90
    ds_bpermute_b32 v91, v119, v91
    ds_bpermute_b32 v92, v119, v92
    ds_bpermute_b32 v93, v119, v93
    ds_bpermute_b32 v94, v119, v94
    ds_bpermute_b32 v95, v119, v95
    ds_read_b64_tr_b16 v[208:209], v84 offset:0
    ds_read_b64_tr_b16 v[210:211], v85 offset:0
    ds_read_b64_tr_b16 v[212:213], v84 offset:5120
    ds_read_b64_tr_b16 v[214:215], v85 offset:5120
    ds_read_b64_tr_b16 v[216:217], v86 offset:32
    ds_read_b64_tr_b16 v[218:219], v87 offset:32
    s_waitcnt lgkmcnt(13)
    ds_read_b64_tr_b16 v[220:221], v84 offset:1280
    ds_read_b64_tr_b16 v[222:223], v85 offset:1280
    s_waitcnt lgkmcnt(13)
    ds_read_b64_tr_b16 v[224:225], v84 offset:6400
    ds_read_b64_tr_b16 v[226:227], v85 offset:6400
    s_waitcnt lgkmcnt(13)
    ds_read_b64_tr_b16 v[228:229], v86 offset:1312
    ds_read_b64_tr_b16 v[230:231], v87 offset:1312
    s_waitcnt lgkmcnt(13)
    ds_read_b64_tr_b16 v[232:233], v84 offset:2560
    ds_read_b64_tr_b16 v[234:235], v85 offset:2560
    s_waitcnt lgkmcnt(13)
    ds_read_b64_tr_b16 v[236:237], v84 offset:7680
    ds_read_b64_tr_b16 v[238:239], v85 offset:7680
    s_waitcnt lgkmcnt(13)
    ds_read_b64_tr_b16 v[240:241], v86 offset:2592
    ds_read_b64_tr_b16 v[242:243], v87 offset:2592
    s_waitcnt lgkmcnt(13)
    ds_read_b64_tr_b16 v[244:245], v84 offset:3840
    ds_read_b64_tr_b16 v[246:247], v85 offset:3840
    s_waitcnt lgkmcnt(13)
    ds_read_b64_tr_b16 v[248:249], v84 offset:8960
    ds_read_b64_tr_b16 v[250:251], v85 offset:8960
    s_waitcnt lgkmcnt(13)
    ds_read_b64_tr_b16 v[252:253], v86 offset:3872
    ds_read_b64_tr_b16 v[254:255], v87 offset:3872
    v_cndmask_b32 v96, v88, v90, s[58:59]
    v_cndmask_b32 v97, v89, v91, s[58:59]
    v_cndmask_b32 v98, v90, v88, s[58:59]
    v_cndmask_b32 v99, v91, v89, s[58:59]
    v_cndmask_b32 v100, v92, v94, s[58:59]
    v_cndmask_b32 v101, v93, v95, s[58:59]
    v_cndmask_b32 v102, v94, v92, s[58:59]
    v_cndmask_b32 v103, v95, v93, s[58:59]
    v_lshlrev_b32 v64, 16, v96
    v_and_b32 v65, 0xffff0000, v96
    v_lshlrev_b32 v66, 16, v97
    v_and_b32 v67, 0xffff0000, v97
    v_lshlrev_b32 v68, 16, v98
    v_and_b32 v69, 0xffff0000, v98
    v_lshlrev_b32 v70, 16, v99
    v_and_b32 v71, 0xffff0000, v99
    v_lshlrev_b32 v72, 16, v100
    v_and_b32 v73, 0xffff0000, v100
    v_lshlrev_b32 v74, 16, v101
    v_and_b32 v75, 0xffff0000, v101
    v_lshlrev_b32 v76, 16, v102
    v_and_b32 v77, 0xffff0000, v102
    v_lshlrev_b32 v78, 16, v103
    v_and_b32 v79, 0xffff0000, v103
    v_lshlrev_b32 v52, 16, v52
    v_lshlrev_b32 v53, 16, v53
    v_lshlrev_b32 v54, 16, v54
    v_mul_f32 v96, 0xbfb8aa3b, v52
    v_mul_f32 v97, 0xbfb8aa3b, v53
    v_mul_f32 v98, 0xbfb8aa3b, v54
    v_exp_f32 v96, v96
    v_exp_f32 v97, v97
    v_exp_f32 v98, v98
    v_add_f32 v96, 1.0, v96
    v_add_f32 v97, 1.0, v97
    v_add_f32 v98, 1.0, v98
    v_rcp_f32 v96, v96
    v_rcp_f32 v97, v97
    v_rcp_f32 v98, v98
    v_mul_f32 v96, v96, v52
    v_mul_f32 v97, v97, v53
    v_mul_f32 v98, v98, v54
    v_and_b32 v99, 1, v1
    v_lshlrev_b32 v99, 4, v99
    s_sub_u32 s52, s7, 1
    v_cvt_pk_bf16_f32 v96, v96, 0
    v_cvt_pk_bf16_f32 v97, v97, 0
    v_cvt_pk_bf16_f32 v98, v98, 0
    v_lshlrev_b32 v96, v99, v96
    v_lshlrev_b32 v97, v99, v97
    v_lshlrev_b32 v98, v99, v98
    v_and_b32 v98, s52, v98
    v_bfe_u32 v99, v1, 1, 2
    v_xor_b32 v52, 0, v99
    v_subrev_u32 v52, 1, v52
    v_ashrrev_i32 v52, 31, v52
    v_and_b32 v34, v52, v96
    v_and_b32 v38, v52, v97
    v_and_b32 v42, v52, v98
    v_xor_b32 v52, 1, v99
    v_subrev_u32 v52, 1, v52
    v_ashrrev_i32 v52, 31, v52
    v_and_b32 v35, v52, v96
    v_and_b32 v39, v52, v97
    v_and_b32 v43, v52, v98
    v_xor_b32 v52, 2, v99
    v_subrev_u32 v52, 1, v52
    v_ashrrev_i32 v52, 31, v52
    v_and_b32 v36, v52, v96
    v_and_b32 v40, v52, v97
    v_and_b32 v44, v52, v98
    v_xor_b32 v52, 3, v99
    v_subrev_u32 v52, 1, v52
    v_ashrrev_i32 v52, 31, v52
    v_and_b32 v37, v52, v96
    v_and_b32 v41, v52, v97
    v_and_b32 v45, v52, v98
    v_and_b32 v52, 7, v1
    v_lshlrev_b32 v52, 5, v52
    v_and_b32 v53, 1, v3
    v_lshl_add_u32 v52, v53, 4, v52
    v_lshrrev_b32 v53, 5, v1
    v_lshl_add_u32 v52, v53, 8, v52
    s_lshl_b32 s52, s3, 9
    s_add_u32 s52, s52, 106496
    v_add_u32 v54, s52, v52
L_skip_11:
    s_waitcnt lgkmcnt(0)
    v_pk_fma_f32 v[64:65], v[64:65], v[82:83], v[82:83] op_sel:[0,1,0] op_sel_hi:[1,1,0] neg_lo:[0,0,1] neg_hi:[0,0,1]
    v_pk_fma_f32 v[66:67], v[66:67], v[82:83], v[82:83] op_sel:[0,1,0] op_sel_hi:[1,1,0] neg_lo:[0,0,1] neg_hi:[0,0,1]
    v_pk_fma_f32 v[68:69], v[68:69], v[82:83], v[82:83] op_sel:[0,1,0] op_sel_hi:[1,1,0] neg_lo:[0,0,1] neg_hi:[0,0,1]
    v_pk_fma_f32 v[70:71], v[70:71], v[82:83], v[82:83] op_sel:[0,1,0] op_sel_hi:[1,1,0] neg_lo:[0,0,1] neg_hi:[0,0,1]
    v_pk_fma_f32 v[72:73], v[72:73], v[82:83], v[82:83] op_sel:[0,1,0] op_sel_hi:[1,1,0] neg_lo:[0,0,1] neg_hi:[0,0,1]
    v_pk_fma_f32 v[74:75], v[74:75], v[82:83], v[82:83] op_sel:[0,1,0] op_sel_hi:[1,1,0] neg_lo:[0,0,1] neg_hi:[0,0,1]
    v_pk_fma_f32 v[76:77], v[76:77], v[82:83], v[82:83] op_sel:[0,1,0] op_sel_hi:[1,1,0] neg_lo:[0,0,1] neg_hi:[0,0,1]
    v_pk_fma_f32 v[78:79], v[78:79], v[82:83], v[82:83] op_sel:[0,1,0] op_sel_hi:[1,1,0] neg_lo:[0,0,1] neg_hi:[0,0,1]
    s_waitcnt vmcnt(0)
    v_xor_b32 v8, s86, v8
    v_xor_b32 v9, s87, v9
    v_xor_b32 v10, s88, v10
    v_xor_b32 v11, s89, v11
    v_xor_b32 v12, s86, v12
    v_xor_b32 v13, s87, v13
    v_xor_b32 v14, s88, v14
    v_xor_b32 v15, s89, v15
    v_xor_b32 v16, s86, v16
    v_xor_b32 v17, s87, v17
    v_xor_b32 v18, s88, v18
    v_xor_b32 v19, s89, v19
    v_xor_b32 v20, s86, v20
    v_xor_b32 v21, s87, v21
    v_xor_b32 v22, s88, v22
    v_xor_b32 v23, s89, v23
    v_or_b32 v27, v8, v9
    v_or3_b32 v27, v27, v10, v11
    v_or3_b32 v27, v27, v12, v13
    v_or3_b32 v27, v27, v14, v15
    v_or3_b32 v27, v27, v16, v17
    v_or3_b32 v27, v27, v18, v19
    v_or3_b32 v27, v27, v20, v21
    v_or3_b32 v27, v27, v22, v23
    v_and_b32 v27, 0xff, v27
    v_cmp_ne_u32 vcc, 0, v27
    s_cbranch_vccnz L_h1retry
L_h1ok:
    v_pk_add_f32 v[8:9], v[8:9], v[12:13]
    v_pk_add_f32 v[16:17], v[16:17], v[20:21]
    v_pk_add_f32 v[10:11], v[10:11], v[14:15]
    v_pk_add_f32 v[18:19], v[18:19], v[22:23]
    v_pk_add_f32 v[8:9], v[8:9], v[16:17]
    v_pk_add_f32 v[10:11], v[10:11], v[18:19]
    v_cvt_pk_bf16_f32 v8, 0, v8
    v_cvt_pk_bf16_f32 v9, 0, v9
    v_cvt_pk_bf16_f32 v10, 0, v10
    v_cvt_pk_bf16_f32 v11, 0, v11
    v_add_f32 v8, v25, v8
    v_add_f32 v9, v25, v9
    v_add_f32 v10, v25, v10
    v_add_f32 v11, v25, v11
    v_cvt_pk_bf16_f32 v8, 0, v8
    v_cvt_pk_bf16_f32 v9, 0, v9
    v_cvt_pk_bf16_f32 v10, 0, v10
    v_cvt_pk_bf16_f32 v11, 0, v11
    s_waitcnt lgkmcnt(0)
    ds_write_b128 v121, v[8:11]
    ds_read_b128 v[80:83], v122 offset:512
    ds_read_b128 v[84:87], v123 offset:512
    ds_read_b128 v[88:91], v122 offset:0
    ds_read_b128 v[92:95], v123 offset:0
    ds_read_b128 v[96:99], v122 offset:768
    ds_read_b128 v[100:103], v123 offset:768
    ds_read_b128 v[104:107], v122 offset:256
    ds_read_b128 v[108:111], v123 offset:256
    s_waitcnt lgkmcnt(4)
    v_pk_fma_f32 v[64:65], v[64:65], v[80:81], v[88:89]
    v_pk_fma_f32 v[66:67], v[66:67], v[82:83], v[90:91]
    v_pk_fma_f32 v[68:69], v[68:69], v[84:85], v[92:93]
    v_pk_fma_f32 v[70:71], v[70:71], v[86:87], v[94:95]
    v_cvt_pk_bf16_f32 v112, v64, v65
    v_cvt_pk_bf16_f32 v113, v66, v67
    v_cvt_pk_bf16_f32 v114, v68, v69
    v_cvt_pk_bf16_f32 v115, v70, v71
    buffer_store_dwordx4 v[112:115], v24, s[32:35], s50 offen sc1
    s_waitcnt lgkmcnt(0)
    v_pk_fma_f32 v[72:73], v[72:73], v[96:97], v[104:105]
    v_pk_fma_f32 v[74:75], v[74:75], v[98:99], v[106:107]
    v_pk_fma_f32 v[76:77], v[76:77], v[100:101], v[108:109]
    v_pk_fma_f32 v[78:79], v[78:79], v[102:103], v[110:111]
    v_cvt_pk_bf16_f32 v116, v72, v73
    v_cvt_pk_bf16_f32 v117, v74, v75
    v_cvt_pk_bf16_f32 v118, v76, v77
    v_cvt_pk_bf16_f32 v119, v78, v79
    buffer_store_dwordx4 v[116:119], v24, s[32:35], s51 offen sc1
    ds_write_b128 v121, v[112:115] offset:1024
    ds_write_b128 v121, v[116:119] offset:2048
    s_setprio 1
    ds_read_b128 v[80:83], v125 offset:1024
    ds_read_b128 v[84:87], v125 offset:1536
    ds_read_b128 v[88:91], v125 offset:2048
    ds_read_b128 v[92:95], v125 offset:2560
    v_add3_u32 v27, v112, v113, v114
    v_add3_u32 v25, v116, v117, v118
    v_add_u32 v27, v27, v115
    v_add_u32 v25, v25, v119
    s_waitcnt lgkmcnt(3)
    v_mfma_f32_16x16x32_bf16 v[96:99], v[208:211], v[80:83], 0
    v_mfma_f32_16x16x32_bf16 v[100:103], v[216:219], v[80:83], 0
    v_mfma_f32_16x16x32_bf16 v[104:107], v[80:83], v[212:215], 0
    v_mfma_f32_16x16x32_bf16 v[108:111], v[80:83], v[216:219], 0
    s_waitcnt lgkmcnt(2)
    v_mfma_f32_16x16x32_bf16 v[96:99], v[220:223], v[84:87], v[96:99]
    v_mfma_f32_16x16x32_bf16 v[100:103], v[228:231], v[84:87], v[100:103]
    v_mfma_f32_16x16x32_bf16 v[104:107], v[84:87], v[224:227], v[104:107]
    v_mfma_f32_16x16x32_bf16 v[108:111], v[84:87], v[228:231], v[108:111]
    s_waitcnt lgkmcnt(1)
    v_mfma_f32_16x16x32_bf16 v[96:99], v[232:235], v[88:91], v[96:99]
    v_mfma_f32_16x16x32_bf16 v[100:103], v[240:243], v[88:91], v[100:103]
    v_mfma_f32_16x16x32_bf16 v[104:107], v[88:91], v[236:239], v[104:107]
    v_mfma_f32_16x16x32_bf16 v[108:111], v[88:91], v[240:243], v[108:111]
    s_waitcnt lgkmcnt(0)
    v_mfma_f32_16x16x32_bf16 v[96:99], v[244:247], v[92:95], v[96:99]
    v_mfma_f32_16x16x32_bf16 v[100:103], v[252:255], v[92:95], v[100:103]
    v_mfma_f32_16x16x32_bf16 v[104:107], v[92:95], v[248:251], v[104:107]
    v_mfma_f32_16x16x32_bf16 v[108:111], v[92:95], v[252:255], v[108:111]
    ds_write2st64_b32 v124, v27, v25 offset0:0 offset1:1
    s_mov_b32 exec_lo, 0x00ff00ff
    s_mov_b32 exec_hi, 0x00ff00ff
    s_nop 1
    ds_write_b128 v126, v[96:99]
    s_mov_b64 exec, 0xff
    ds_write_b128 v126, v[100:103] offset:64
    s_mov_b32 exec_lo, -1
    ds_write_b128 v127, v[104:107] offset:640
    s_mov_b32 exec_lo, 0x00f000f0
    ds_write_b128 v127, v[108:111] offset:1024
    s_mov_b64 exec, -1
    s_setprio 0
    s_branch L_bkv_7
L_w0_8:
    s_cmp_lt_u32 s2, 160
    s_cbranch_scc0 L_skip_12
    s_waitcnt vmcnt(16)
    v_lshlrev_b32 v80, 16, v208
    v_and_b32 v81, 0xffff0000, v208
    v_lshlrev_b32 v82, 16, v209
    v_and_b32 v83, 0xffff0000, v209
    v_lshlrev_b32 v84, 16, v210
    v_and_b32 v85, 0xffff0000, v210
    v_lshlrev_b32 v86, 16, v211
    v_and_b32 v87, 0xffff0000, v211
    v_lshlrev_b32 v88, 16, v212
    v_and_b32 v89, 0xffff0000, v212
    v_mul_f32 v90, 0xbfb8aa3b, v80
    v_mul_f32 v91, 0xbfb8aa3b, v81
    v_mul_f32 v92, 0xbfb8aa3b, v82
    v_mul_f32 v93, 0xbfb8aa3b, v83
    v_mul_f32 v94, 0xbfb8aa3b, v84
    v_mul_f32 v95, 0xbfb8aa3b, v85
    v_mul_f32 v96, 0xbfb8aa3b, v86
    v_mul_f32 v97, 0xbfb8aa3b, v87
    v_mul_f32 v98, 0xbfb8aa3b, v88
    v_mul_f32 v99, 0xbfb8aa3b, v89
    v_exp_f32 v90, v90
    v_exp_f32 v91, v91
    v_exp_f32 v92, v92
    v_exp_f32 v93, v93
    v_exp_f32 v94, v94
    v_exp_f32 v95, v95
    v_exp_f32 v96, v96
    v_exp_f32 v97, v97
    v_exp_f32 v98, v98
    v_exp_f32 v99, v99
    v_add_f32 v90, 1.0, v90
    v_add_f32 v91, 1.0, v91
    v_add_f32 v92, 1.0, v92
    v_add_f32 v93, 1.0, v93
    v_add_f32 v94, 1.0, v94
    v_add_f32 v95, 1.0, v95
    v_add_f32 v96, 1.0, v96
    v_add_f32 v97, 1.0, v97
    v_add_f32 v98, 1.0, v98
    v_add_f32 v99, 1.0, v99
    v_rcp_f32 v90, v90
    v_rcp_f32 v91, v91
    v_rcp_f32 v92, v92
    v_rcp_f32 v93, v93
    v_rcp_f32 v94, v94
    v_rcp_f32 v95, v95
    v_rcp_f32 v96, v96
    v_rcp_f32 v97, v97
    v_rcp_f32 v98, v98
    v_rcp_f32 v99, v99
    v_mul_f32 v90, v90, v80
    v_mul_f32 v91, v91, v81
    v_mul_f32 v92, v92, v82
    v_mul_f32 v93, v93, v83
    v_mul_f32 v94, v94, v84
    v_mul_f32 v95, v95, v85
    v_mul_f32 v96, v96, v86
    v_mul_f32 v97, v97, v87
    v_mul_f32 v98, v98, v88
    v_mul_f32 v99, v99, v89
    v_cvt_pk_bf16_f32 v80, v90, 0
    v_cvt_pk_bf16_f32 v81, v91, 0
    v_cvt_pk_bf16_f32 v82, v92, 0
    v_cvt_pk_bf16_f32 v83, v93, 0
    v_cvt_pk_bf16_f32 v84, v94, 0
    v_cvt_pk_bf16_f32 v85, v95, 0
    v_cvt_pk_bf16_f32 v86, v96, 0
    v_cvt_pk_bf16_f32 v87, v97, 0
    v_cvt_pk_bf16_f32 v88, v98, 0
    v_cvt_pk_bf16_f32 v89, v99, 0
    v_lshlrev_b32 v90, 16, v80
    v_lshlrev_b32 v91, 16, v81
    v_lshlrev_b32 v92, 16, v82
    v_lshlrev_b32 v93, 16, v83
    v_lshlrev_b32 v94, 16, v84
    v_lshlrev_b32 v95, 16, v85
    v_lshlrev_b32 v96, 16, v86
    v_lshlrev_b32 v97, 16, v87
    v_lshlrev_b32 v98, 16, v88
    v_lshlrev_b32 v99, 16, v89
    v_readfirstlane_b32 s48, v63
    s_getreg_b32 s91, hwreg(HW_REG_XCC_ID, 0, 4)
    s_nop 2
    s_add_u32 s48, s48, 0x01010101
    s_xor_b32 s91, s91, s48
    v_bfe_u32 v72, v1, 4, 1
    v_lshlrev_b32 v72, 4, v72
    v_lshrrev_b32 v72, v72, s48
    v_lshrrev_b32 v73, 8, v72
    v_and_b32 v74, 3, v1
    v_lshlrev_b32 v74, 5, v74
    v_lshl_add_u32 v74, v3, 3, v74
    v_and_b32 v75, 12, v1
    v_lshl_add_u32 v74, v75, 26, v74
    s_movk_i32 s50, 0xff
    s_waitcnt vmcnt(15)
    v_dot2_f32_bf16 v64, v216, v80, 0
    v_dot2_f32_bf16 v65, v216, v90, 0
    v_dot2_f32_bf16 v66, v217, v80, 0
    v_dot2_f32_bf16 v67, v217, v90, 0
    v_dot2_f32_bf16 v68, v218, v80, 0
    v_dot2_f32_bf16 v69, v218, v90, 0
    v_dot2_f32_bf16 v70, v219, v80, 0
    v_dot2_f32_bf16 v71, v219, v90, 0
    s_waitcnt vmcnt(14)
    v_dot2_f32_bf16 v64, v220, v81, v64
    v_dot2_f32_bf16 v65, v220, v91, v65
    v_dot2_f32_bf16 v66, v221, v81, v66
    v_dot2_f32_bf16 v67, v221, v91, v67
    v_dot2_f32_bf16 v68, v222, v81, v68
    v_dot2_f32_bf16 v69, v222, v91, v69
    v_dot2_f32_bf16 v70, v223, v81, v70
    v_dot2_f32_bf16 v71, v223, v91, v71
    s_waitcnt vmcnt(13)
    v_dot2_f32_bf16 v64, v224, v82, v64
    v_dot2_f32_bf16 v65, v224, v92, v65
    v_dot2_f32_bf16 v66, v225, v82, v66
    v_dot2_f32_bf16 v67, v225, v92, v67
    v_dot2_f32_bf16 v68, v226, v82, v68
    v_dot2_f32_bf16 v69, v226, v92, v69
    v_dot2_f32_bf16 v70, v227, v82, v70
    v_dot2_f32_bf16 v71, v227, v92, v71
    s_waitcnt vmcnt(12)
    v_dot2_f32_bf16 v64, v228, v83, v64
    v_dot2_f32_bf16 v65, v228, v93, v65
    v_dot2_f32_bf16 v66, v229, v83, v66
    v_dot2_f32_bf16 v67, v229, v93, v67
    v_dot2_f32_bf16 v68, v230, v83, v68
    v_dot2_f32_bf16 v69, v230, v93, v69
    v_dot2_f32_bf16 v70, v231, v83, v70
    v_dot2_f32_bf16 v71, v231, v93, v71
    s_waitcnt vmcnt(11)
    v_dot2_f32_bf16 v64, v232, v84, v64
    v_dot2_f32_bf16 v65, v232, v94, v65
    v_dot2_f32_bf16 v66, v233, v84, v66
    v_dot2_f32_bf16 v67, v233, v94, v67
    v_dot2_f32_bf16 v68, v234, v84, v68
    v_dot2_f32_bf16 v69, v234, v94, v69
    v_dot2_f32_bf16 v70, v235, v84, v70
    v_dot2_f32_bf16 v71, v235, v94, v71
    s_waitcnt vmcnt(10)
    v_dot2_f32_bf16 v64, v236, v85, v64
    v_dot2_f32_bf16 v65, v236, v95, v65
    v_dot2_f32_bf16 v66, v237, v85, v66
    v_dot2_f32_bf16 v67, v237, v95, v67
    v_dot2_f32_bf16 v68, v238, v85, v68
    v_dot2_f32_bf16 v69, v238, v95, v69
    v_dot2_f32_bf16 v70, v239, v85, v70
    v_dot2_f32_bf16 v71, v239, v95, v71
    s_waitcnt vmcnt(9)
    v_dot2_f32_bf16 v64, v240, v86, v64
    v_dot2_f32_bf16 v65, v240, v96, v65
    v_dot2_f32_bf16 v66, v241, v86, v66
    v_dot2_f32_bf16 v67, v241, v96, v67
    v_dot2_f32_bf16 v68, v242, v86, v68
    v_dot2_f32_bf16 v69, v242, v96, v69
    v_dot2_f32_bf16 v70, v243, v86, v70
    v_dot2_f32_bf16 v71, v243, v96, v71
    s_waitcnt vmcnt(8)
    v_dot2_f32_bf16 v64, v244, v87, v64
    v_dot2_f32_bf16 v65, v244, v97, v65
    v_dot2_f32_bf16 v66, v245, v87, v66
    v_dot2_f32_bf16 v67, v245, v97, v67
    v_dot2_f32_bf16 v68, v246, v87, v68
    v_dot2_f32_bf16 v69, v246, v97, v69
    v_dot2_f32_bf16 v70, v247, v87, v70
    v_dot2_f32_bf16 v71, v247, v97, v71
    s_waitcnt vmcnt(7)
    v_dot2_f32_bf16 v64, v248, v88, v64
    v_dot2_f32_bf16 v65, v248, v98, v65
    v_dot2_f32_bf16 v66, v249, v88, v66
    v_dot2_f32_bf16 v67, v249, v98, v67
    v_dot2_f32_bf16 v68, v250, v88, v68
    v_dot2_f32_bf16 v69, v250, v98, v69
    v_dot2_f32_bf16 v70, v251, v88, v70
    v_dot2_f32_bf16 v71, v251, v98, v71
    s_waitcnt vmcnt(6)
    v_dot2_f32_bf16 v64, v252, v89, v64
    v_dot2_f32_bf16 v65, v252, v99, v65
    v_dot2_f32_bf16 v66, v253, v89, v66
    v_dot2_f32_bf16 v67, v253, v99, v67
    v_dot2_f32_bf16 v68, v254, v89, v68
    v_dot2_f32_bf16 v69, v254, v99, v69
    v_dot2_f32_bf16 v70, v255, v89, v70
    v_dot2_f32_bf16 v71, v255, v99, v71
    s_nop 2
    v_permlane32_swap_b32 v64, v68
    v_permlane32_swap_b32 v65, v69
    v_permlane32_swap_b32 v66, v70
    v_permlane32_swap_b32 v67, v71
    v_add_f32 v64, v64, v68
    v_add_f32 v65, v65, v69
    v_add_f32 v66, v66, v70
    v_add_f32 v67, v67, v71
    s_nop 1
    v_permlane16_swap_b32 v64, v66
    v_permlane16_swap_b32 v65, v67
    v_add_f32 v64, v64, v66
    v_add_f32 v65, v65, v67
    s_nop 1
    v_add_f32_dpp v64, v64, v64 row_ror:8 row_mask:0xf bank_mask:0xf
    v_add_f32_dpp v65, v65, v65 row_ror:8 row_mask:0xf bank_mask:0xf
    s_nop 1
    v_add_f32_dpp v64, v64, v64 row_ror:4 row_mask:0xf bank_mask:0xf
    v_add_f32_dpp v65, v65, v65 row_ror:4 row_mask:0xf bank_mask:0xf
    v_bfi_b32 v64, s50, v72, v64
    v_bfi_b32 v65, s50, v73, v65
    buffer_store_dwordx2 v[64:65], v74, s[32:35], s59 offen sc1
    s_setprio 0
L_skip_12:
    v_lshlrev_b32 v80, 2, v2
    v_add_u32 v80, 163072, v80
    v_mov_b32 v81, 0
    ds_write_b32 v80, v81
    s_waitcnt vmcnt(1)
    s_mov_b32 s52, 0x3f803f80
    v_dot2_f32_bf16 v110, v104, s52, 0
    v_dot2_f32_bf16 v111, v104, v104, 0
    v_dot2_f32_bf16 v110, v105, s52, v110
    v_dot2_f32_bf16 v111, v105, v105, v111
    v_dot2_f32_bf16 v110, v106, s52, v110
    v_dot2_f32_bf16 v111, v106, v106, v111
    v_dot2_f32_bf16 v110, v107, s52, v110
    v_dot2_f32_bf16 v111, v107, v107, v111
    v_dot2_f32_bf16 v110, v108, s52, v110
    v_dot2_f32_bf16 v111, v108, v108, v111
    s_nop 2
    v_add_f32_dpp v110, v110, v110 row_ror:8 row_mask:0xf bank_mask:0xf
    v_add_f32_dpp v111, v111, v111 row_ror:8 row_mask:0xf bank_mask:0xf
    s_nop 0
    v_add_f32_dpp v110, v110, v110 row_ror:4 row_mask:0xf bank_mask:0xf
    v_add_f32_dpp v111, v111, v111 row_ror:4 row_mask:0xf bank_mask:0xf
    s_nop 0
    v_add_f32_dpp v110, v110, v110 row_ror:2 row_mask:0xf bank_mask:0xf
    v_add_f32_dpp v111, v111, v111 row_ror:2 row_mask:0xf bank_mask:0xf
    s_nop 0
    v_add_f32_dpp v110, v110, v110 row_ror:1 row_mask:0xf bank_mask:0xf
    v_add_f32_dpp v111, v111, v111 row_ror:1 row_mask:0xf bank_mask:0xf
    s_nop 0
    v_mov_b32 v104, v110
    v_mov_b32 v105, v111
    s_nop 1
    v_permlane32_swap_b32 v110, v104
    v_permlane32_swap_b32 v111, v105
    v_add_f32 v110, v110, v104
    v_add_f32 v111, v111, v105
    v_mov_b32 v104, v110
    v_mov_b32 v105, v111
    s_nop 1
    v_permlane16_swap_b32 v110, v104
    v_permlane16_swap_b32 v111, v105
    v_add_f32 v110, v110, v104
    v_add_f32 v111, v111, v105
    v_mul_f32 v110, 0x3acccccd, v110
    v_mul_f32 v111, 0x3acccccd, v111
    v_fma_f32 v111, -v110, v110, v111
    v_max_f32 v111, 0, v111
    v_add_f32 v111, 0x3727c5ac, v111
    v_rsq_f32 v111, v111
    s_lshl_b32 s52, s3, 3
    s_add_u32 s52, s52, 162816
    v_mul_f32 v110, v110, v111
    v_mov_b32 v109, s52
    s_mov_b64 exec, 1
    ds_write_b64 v109, v[110:111]
    s_mov_b64 exec, -1
    s_waitcnt lgkmcnt(0)
    s_barrier
    s_waitcnt vmcnt(0)
    v_lshlrev_b32 v52, 16, v52
    v_lshlrev_b32 v53, 16, v53
    v_lshlrev_b32 v54, 16, v54
    v_mul_f32 v80, 0xbfb8aa3b, v52
    v_mul_f32 v81, 0xbfb8aa3b, v53
    v_mul_f32 v82, 0xbfb8aa3b, v54
    v_exp_f32 v80, v80
    v_exp_f32 v81, v81
    v_exp_f32 v82, v82
    v_add_f32 v80, 1.0, v80
    v_add_f32 v81, 1.0, v81
    v_add_f32 v82, 1.0, v82
    v_rcp_f32 v80, v80
    v_rcp_f32 v81, v81
    v_rcp_f32 v82, v82
    v_mul_f32 v80, v80, v52
    v_mul_f32 v81, v81, v53
    v_mul_f32 v82, v82, v54
    v_and_b32 v83, 1, v1
    v_lshlrev_b32 v83, 4, v83
    s_sub_u32 s52, s7, 1
    v_cvt_pk_bf16_f32 v80, v80, 0
    v_cvt_pk_bf16_f32 v81, v81, 0
    v_cvt_pk_bf16_f32 v82, v82, 0
    v_lshlrev_b32 v80, v83, v80
    v_lshlrev_b32 v81, v83, v81
    v_lshlrev_b32 v82, v83, v82
    v_and_b32 v82, s52, v82
    v_bfe_u32 v83, v1, 1, 2
    v_xor_b32 v52, 0, v83
    v_subrev_u32 v52, 1, v52
    v_ashrrev_i32 v52, 31, v52
    v_and_b32 v34, v52, v80
    v_and_b32 v38, v52, v81
    v_and_b32 v42, v52, v82
    v_xor_b32 v52, 1, v83
    v_subrev_u32 v52, 1, v52
    v_ashrrev_i32 v52, 31, v52
    v_and_b32 v35, v52, v80
    v_and_b32 v39, v52, v81
    v_and_b32 v43, v52, v82
    v_xor_b32 v52, 2, v83
    v_subrev_u32 v52, 1, v52
    v_ashrrev_i32 v52, 31, v52
    v_and_b32 v36, v52, v80
    v_and_b32 v40, v52, v81
    v_and_b32 v44, v52, v82
    v_xor_b32 v52, 3, v83
    v_subrev_u32 v52, 1, v52
    v_ashrrev_i32 v52, 31, v52
    v_and_b32 v37, v52, v80
    v_and_b32 v41, v52, v81
    v_and_b32 v45, v52, v82
    v_and_b32 v52, 7, v1
    v_lshlrev_b32 v52, 5, v52
    v_and_b32 v53, 1, v3
    v_lshl_add_u32 v52, v53, 4, v52
    v_lshrrev_b32 v53, 5, v1
    v_lshl_add_u32 v52, v53, 8, v52
    s_lshl_b32 s52, s3, 9
    s_add_u32 s52, s52, 106496
    v_add_u32 v54, s52, v52
    v_readfirstlane_b32 s48, v63
    s_getreg_b32 s91, hwreg(HW_REG_XCC_ID, 0, 4)
    s_nop 2
    s_add_u32 s48, s48, 0x01010101
    s_xor_b32 s91, s91, s48
    s_and_b32 s86, s48, 0xff
    s_bfe_u32 s87, s48, 0x80008
    s_bfe_u32 s88, s48, 0x80010
    s_lshr_b32 s89, s48, 24
    v_mul_u32_u24 v112, 52, v1
    v_lshrrev_b32 v112, 8, v112
    v_mul_u32_u24 v113, 5, v112
    v_sub_u32 v113, v1, v113
    s_and_b32 s50, s5, 3
    s_lshl_b32 s50, s50, 3
    v_add_u32 v112, s50, v112
    s_lshr_b32 s50, s5, 2
    s_mul_i32 s51, s50, 3072
    v_lshrrev_b32 v114, 1, v113
    v_lshl_add_u32 v114, v114, 5, v112
    v_and_b32 v115, 1, v113
    v_lshlrev_b32 v115, 3, v115
    v_lshl_add_u32 v114, v114, 4, v115
    v_add_u32 v114, s51, v114
    s_lshl_b32 s50, s50, 8
    s_add_u32 s50, s50, 2560
    v_cmp_eq_u32 vcc, 4, v113
    v_lshl_add_u32 v112, v112, 3, s50
    s_mul_i32 s54, s4, 6144
    v_cndmask_b32 v112, v114, v112, vcc
    s_add_u32 s54, s54, 655360
    s_bfe_u32 s50, s5, 0x10001
    s_mul_i32 s50, s50, 768
    s_add_u32 s55, s54, s51
    s_add_u32 s55, s55, s50
    s_and_b32 s50, s5, 1
    s_mul_i32 s56, s50, 0x300
    s_or_b32 s56, s56, 0xff
    s_mul_i32 s50, s50, 320
    s_add_u32 s55, s55, s50
    s_add_u32 s55, s55, 1024
    v_add_u32 v113, 153600, v4
    v_mov_b32 v116, 0x3f803f80
    v_mov_b32 v117, 0x3f803f80
    s_waitcnt vmcnt(0)
    s_branch L_bkv_7
L_dma2_9:
    s_and_b32 s57, s3, 1
    s_mul_i32 s57, s57, 1
    v_mov_b32 v181, v1
    v_mul_u32_u24 v182, 6554, v181
    v_lshrrev_b32 v182, 16, v182
    v_mul_u32_u24 v183, 10, v182
    v_sub_u32 v183, v181, v183
    v_mul_u32_u24 v182, 1280, v182
    v_lshl_add_u32 v176, v183, 4, v182
    v_add_u32 v181, 64, v181
    v_mul_u32_u24 v182, 6554, v181
    v_lshrrev_b32 v182, 16, v182
    v_mul_u32_u24 v183, 10, v182
    v_sub_u32 v183, v181, v183
    v_mul_u32_u24 v182, 1280, v182
    v_lshl_add_u32 v177, v183, 4, v182
    v_add_u32 v181, 64, v181
    v_mul_u32_u24 v182, 6554, v181
    v_lshrrev_b32 v182, 16, v182
    v_mul_u32_u24 v183, 10, v182
    v_sub_u32 v183, v181, v183
    v_mul_u32_u24 v182, 1280, v182
    v_lshl_add_u32 v178, v183, 4, v182
    v_add_u32 v181, 64, v181
    v_mul_u32_u24 v182, 6554, v181
    v_lshrrev_b32 v182, 16, v182
    v_mul_u32_u24 v183, 10, v182
    v_sub_u32 v183, v181, v183
    v_mul_u32_u24 v182, 1280, v182
    v_lshl_add_u32 v179, v183, 4, v182
    v_add_u32 v181, 64, v181
    v_mul_u32_u24 v182, 6554, v181
    v_lshrrev_b32 v182, 16, v182
    v_mul_u32_u24 v183, 10, v182
    v_sub_u32 v183, v181, v183
    v_mul_u32_u24 v182, 1280, v182
    v_lshl_add_u32 v180, v183, 4, v182
    s_setprio 0
    s_mul_i32 s55, s57, 5120
    s_mul_i32 s54, s57, 40960
    s_add_u32 s54, s54, s90
    s_add_u32 s56, s55, 20480
L_qloop_13:
    s_mov_b32 m0, s55
    s_addk_i32 s55, 1024
    buffer_load_dwordx4 v176, s[12:15], s54 offen  lds
    s_mov_b32 m0, s55
    s_addk_i32 s55, 1024
    buffer_load_dwordx4 v177, s[12:15], s54 offen  lds
    s_mov_b32 m0, s55
    s_addk_i32 s55, 1024
    buffer_load_dwordx4 v178, s[12:15], s54 offen  lds
    s_mov_b32 m0, s55
    s_addk_i32 s55, 1024
    buffer_load_dwordx4 v179, s[12:15], s54 offen  lds
    s_mov_b32 m0, s55
    s_addk_i32 s55, 1024
    buffer_load_dwordx4 v180, s[12:15], s54 offen  lds
    s_addk_i32 s55, 5120
    s_add_u32 s54, s54, 81920
    s_cmp_lt_u32 s55, s56
    s_cbranch_scc1 L_qloop_13
    s_add_u32 s57, s57, 4
    s_waitcnt vmcnt(10)
    s_mov_b32 s52, 0x3f803f80
    v_dot2_f32_bf16 v110, v104, s52, 0
    v_dot2_f32_bf16 v111, v104, v104, 0
    v_dot2_f32_bf16 v110, v105, s52, v110
    v_dot2_f32_bf16 v111, v105, v105, v111
    v_dot2_f32_bf16 v110, v106, s52, v110
    v_dot2_f32_bf16 v111, v106, v106, v111
    v_dot2_f32_bf16 v110, v107, s52, v110
    v_dot2_f32_bf16 v111, v107, v107, v111
    v_dot2_f32_bf16 v110, v108, s52, v110
    v_dot2_f32_bf16 v111, v108, v108, v111
    s_nop 2
    v_add_f32_dpp v110, v110, v110 row_ror:8 row_mask:0xf bank_mask:0xf
    v_add_f32_dpp v111, v111, v111 row_ror:8 row_mask:0xf bank_mask:0xf
    s_nop 0
    v_add_f32_dpp v110, v110, v110 row_ror:4 row_mask:0xf bank_mask:0xf
    v_add_f32_dpp v111, v111, v111 row_ror:4 row_mask:0xf bank_mask:0xf
    s_nop 0
    v_add_f32_dpp v110, v110, v110 row_ror:2 row_mask:0xf bank_mask:0xf
    v_add_f32_dpp v111, v111, v111 row_ror:2 row_mask:0xf bank_mask:0xf
    s_nop 0
    v_add_f32_dpp v110, v110, v110 row_ror:1 row_mask:0xf bank_mask:0xf
    v_add_f32_dpp v111, v111, v111 row_ror:1 row_mask:0xf bank_mask:0xf
    s_nop 0
    v_mov_b32 v104, v110
    v_mov_b32 v105, v111
    s_nop 1
    v_permlane32_swap_b32 v110, v104
    v_permlane32_swap_b32 v111, v105
    v_add_f32 v110, v110, v104
    v_add_f32 v111, v111, v105
    v_mov_b32 v104, v110
    v_mov_b32 v105, v111
    s_nop 1
    v_permlane16_swap_b32 v110, v104
    v_permlane16_swap_b32 v111, v105
    v_add_f32 v110, v110, v104
    v_add_f32 v111, v111, v105
    v_mul_f32 v110, 0x3acccccd, v110
    v_mul_f32 v111, 0x3acccccd, v111
    v_fma_f32 v111, -v110, v110, v111
    v_max_f32 v111, 0, v111
    v_add_f32 v111, 0x3727c5ac, v111
    v_rsq_f32 v111, v111
    s_lshl_b32 s52, s3, 3
    s_add_u32 s52, s52, 162816
    v_mul_f32 v110, v110, v111
    v_mov_b32 v109, s52
    s_mov_b64 exec, 1
    ds_write_b64 v109, v[110:111]
    s_mov_b64 exec, -1
    s_cmp_eq_u32 s3, 7
    s_cbranch_scc0 L_skip_14
    v_mov_b32 v20, -1
    v_mov_b32 v21, -1
    v_mov_b32 v22, -1
    v_mov_b32 v23, -1
    s_lshl_b32 s52, s2, 10
    s_add_u32 s53, s52, 196608
    buffer_store_dwordx4 v[20:23], v4, s[32:35], s53 offen sc1
    s_cmp_lt_u32 s2, 104
    s_cbranch_scc0 L_skip_14
    s_add_u32 s53, s52, 73728
    buffer_store_dwordx4 v[20:23], v4, s[32:35], s53 offen sc1
L_skip_14:
    s_mul_i32 s55, s57, 5120
    s_mul_i32 s54, s57, 40960
    s_add_u32 s54, s54, s90
    s_add_u32 s56, s55, 30720
L_qloop_15:
    s_mov_b32 m0, s55
    s_addk_i32 s55, 1024
    buffer_load_dwordx4 v176, s[12:15], s54 offen  lds
    s_mov_b32 m0, s55
    s_addk_i32 s55, 1024
    buffer_load_dwordx4 v177, s[12:15], s54 offen  lds
    s_mov_b32 m0, s55
    s_addk_i32 s55, 1024
    buffer_load_dwordx4 v178, s[12:15], s54 offen  lds
    s_mov_b32 m0, s55
    s_addk_i32 s55, 1024
    buffer_load_dwordx4 v179, s[12:15], s54 offen  lds
    s_mov_b32 m0, s55
    s_addk_i32 s55, 1024
    buffer_load_dwordx4 v180, s[12:15], s54 offen  lds
    s_addk_i32 s55, 5120
    s_add_u32 s54, s54, 81920
    s_cmp_lt_u32 s55, s56
    s_cbranch_scc1 L_qloop_15
    s_add_u32 s57, s57, 6
    s_waitcnt lgkmcnt(0)
    s_barrier
    s_mul_i32 s55, s57, 5120
    s_mul_i32 s54, s57, 40960
    s_add_u32 s54, s54, s90
    s_add_u32 s56, s55, 20480
L_qloop_16:
    s_mov_b32 m0, s55
    s_addk_i32 s55, 1024
    buffer_load_dwordx4 v176, s[12:15], s54 offen  lds
    s_mov_b32 m0, s55
    s_addk_i32 s55, 1024
    buffer_load_dwordx4 v177, s[12:15], s54 offen  lds
    s_mov_b32 m0, s55
    s_addk_i32 s55, 1024
    buffer_load_dwordx4 v178, s[12:15], s54 offen  lds
    s_mov_b32 m0, s55
    s_addk_i32 s55, 1024
    buffer_load_dwordx4 v179, s[12:15], s54 offen  lds
    s_mov_b32 m0, s55
    s_addk_i32 s55, 1024
    buffer_load_dwordx4 v180, s[12:15], s54 offen  lds
    s_addk_i32 s55, 5120
    s_add_u32 s54, s54, 81920
    s_cmp_lt_u32 s55, s56
    s_cbranch_scc1 L_qloop_16
    v_lshlrev_b32 v52, 16, v52
    v_lshlrev_b32 v53, 16, v53
    v_lshlrev_b32 v54, 16, v54
    v_mul_f32 v80, 0xbfb8aa3b, v52
    v_mul_f32 v81, 0xbfb8aa3b, v53
    v_mul_f32 v82, 0xbfb8aa3b, v54
    v_exp_f32 v80, v80
    v_exp_f32 v81, v81
    v_exp_f32 v82, v82
    v_add_f32 v80, 1.0, v80
    v_add_f32 v81, 1.0, v81
    v_add_f32 v82, 1.0, v82
    v_rcp_f32 v80, v80
    v_rcp_f32 v81, v81
    v_rcp_f32 v82, v82
    v_mul_f32 v80, v80, v52
    v_mul_f32 v81, v81, v53
    v_mul_f32 v82, v82, v54
    v_and_b32 v83, 1, v1
    v_lshlrev_b32 v83, 4, v83
    s_sub_u32 s52, s7, 1
    v_cvt_pk_bf16_f32 v80, v80, 0
    v_cvt_pk_bf16_f32 v81, v81, 0
    v_cvt_pk_bf16_f32 v82, v82, 0
    v_lshlrev_b32 v80, v83, v80
    v_lshlrev_b32 v81, v83, v81
    v_lshlrev_b32 v82, v83, v82
    v_and_b32 v82, s52, v82
    v_bfe_u32 v83, v1, 1, 2
    v_xor_b32 v52, 0, v83
    v_subrev_u32 v52, 1, v52
    v_ashrrev_i32 v52, 31, v52
    v_and_b32 v34, v52, v80
    v_and_b32 v38, v52, v81
    v_and_b32 v42, v52, v82
    v_xor_b32 v52, 1, v83
    v_subrev_u32 v52, 1, v52
    v_ashrrev_i32 v52, 31, v52
    v_and_b32 v35, v52, v80
    v_and_b32 v39, v52, v81
    v_and_b32 v43, v52, v82
    v_xor_b32 v52, 2, v83
    v_subrev_u32 v52, 1, v52
    v_ashrrev_i32 v52, 31, v52
    v_and_b32 v36, v52, v80
    v_and_b32 v40, v52, v81
    v_and_b32 v44, v52, v82
    v_xor_b32 v52, 3, v83
    v_subrev_u32 v52, 1, v52
    v_ashrrev_i32 v52, 31, v52
    v_and_b32 v37, v52, v80
    v_and_b32 v41, v52, v81
    v_and_b32 v45, v52, v82
    v_and_b32 v52, 7, v1
    v_lshlrev_b32 v52, 5, v52
    v_and_b32 v53, 1, v3
    v_lshl_add_u32 v52, v53, 4, v52
    v_lshrrev_b32 v53, 5, v1
    v_lshl_add_u32 v52, v53, 8, v52
    s_lshl_b32 s52, s3, 9
    s_add_u32 s52, s52, 106496
    v_add_u32 v54, s52, v52
    s_add_u32 s57, s57, 4
    s_mul_i32 s55, s57, 5120
    s_mul_i32 s54, s57, 40960
    s_add_u32 s54, s54, s90
    s_add_u32 s56, s55, 30720
L_qloop_17:
    s_mov_b32 m0, s55
    s_addk_i32 s55, 1024
    buffer_load_dwordx4 v176, s[12:15], s54 offen  lds
    s_mov_b32 m0, s55
    s_addk_i32 s55, 1024
    buffer_load_dwordx4 v177, s[12:15], s54 offen  lds
    s_mov_b32 m0, s55
    s_addk_i32 s55, 1024
    buffer_load_dwordx4 v178, s[12:15], s54 offen  lds
    s_mov_b32 m0, s55
    s_addk_i32 s55, 1024
    buffer_load_dwordx4 v179, s[12:15], s54 offen  lds
    s_mov_b32 m0, s55
    s_addk_i32 s55, 1024
    buffer_load_dwordx4 v180, s[12:15], s54 offen  lds
    s_addk_i32 s55, 5120
    s_add_u32 s54, s54, 81920
    s_cmp_lt_u32 s55, s56
    s_cbranch_scc1 L_qloop_17
    v_readfirstlane_b32 s48, v63
    s_getreg_b32 s91, hwreg(HW_REG_XCC_ID, 0, 4)
    s_nop 2
    s_add_u32 s48, s48, 0x01010101
    s_xor_b32 s91, s91, s48
    s_and_b32 s86, s48, 0xff
    s_bfe_u32 s87, s48, 0x80008
    s_bfe_u32 s88, s48, 0x80010
    s_lshr_b32 s89, s48, 24
    v_mov_b32 v112, 0
    s_waitcnt vmcnt(25)
L_bkv_7:
    s_waitcnt lgkmcnt(0)
    s_barrier
    s_mov_b32 s96, s94
    s_mov_b32 s97, s95
    s_mov_b32 s98, s46
    s_and_b32 s53, s3, 1
    s_mul_i32 s58, s4, 81920
    s_lshl_b32 s50, s7, 12
    s_lshl_b32 s51, s6, 8
    s_add_u32 s50, s50, s51
    s_lshl_b32 s51, s53, 13
    s_add_u32 s50, s50, s51
    s_add_u32 s58, s58, s50
    s_add_u32 s58, s58, 4718592
    s_lshl_b32 s59, s4, 12
    s_lshl_b32 s50, s7, 7
    s_and_b32 s51, s6, 2
    s_lshl_b32 s51, s51, 10
    s_add_u32 s50, s50, s51
    s_lshl_b32 s51, s53, 8
    s_add_u32 s50, s50, s51
    s_add_u32 s59, s59, s50
    s_add_u32 s59, s59, 7340032
    s_xor_b32 s53, s58, 256
    s_lshl_b32 s57, s48, 1
    s_cmp_eq_u32 s3, 0
    s_cbranch_scc0 L_skip_18
    s_mov_b32 exec_hi, 0xff
    ds_read_b128 v[64:67], v113 offset:0
    ds_read_b128 v[68:71], v113 offset:1280
    ds_read_b128 v[72:75], v113 offset:2560
    ds_read_b128 v[76:79], v113 offset:3840
    ds_read_b128 v[80:83], v113 offset:5120
    ds_read_b128 v[84:87], v113 offset:640
    ds_read_b128 v[88:91], v113 offset:1920
    ds_read_b128 v[92:95], v113 offset:3200
    ds_read_b128 v[96:99], v113 offset:4480
    ds_read_b128 v[100:103], v113 offset:5760
    s_waitcnt lgkmcnt(5)
    v_pk_add_f32 v[64:65], v[64:65], v[68:69]
    v_pk_add_f32 v[72:73], v[72:73], v[76:77]
    v_pk_add_f32 v[66:67], v[66:67], v[70:71]
    v_pk_add_f32 v[74:75], v[74:75], v[78:79]
    v_pk_add_f32 v[64:65], v[64:65], v[80:81]
    v_pk_add_f32 v[66:67], v[66:67], v[82:83]
    v_pk_add_f32 v[64:65], v[64:65], v[72:73]
    v_pk_add_f32 v[66:67], v[66:67], v[74:75]
    v_mul_f32 v64, 0x3ea52b5c, v64
    v_mul_f32 v65, 0x3ea52b5c, v65
    v_mul_f32 v66, 0x3ea52b5c, v66
    v_mul_f32 v67, 0x3ea52b5c, v67
    v_cvt_pk_bf16_f32 v114, v64, v65
    v_cvt_pk_bf16_f32 v115, v66, v67
    buffer_store_dwordx2 v[114:115], v112, s[32:35], s54 offen sc1
    s_waitcnt lgkmcnt(0)
    v_pk_add_f32 v[84:85], v[84:85], v[88:89]
    v_pk_add_f32 v[92:93], v[92:93], v[96:97]
    v_pk_add_f32 v[86:87], v[86:87], v[90:91]
    v_pk_add_f32 v[94:95], v[94:95], v[98:99]
    v_pk_add_f32 v[84:85], v[84:85], v[100:101]
    v_pk_add_f32 v[86:87], v[86:87], v[102:103]
    v_pk_add_f32 v[84:85], v[84:85], v[92:93]
    v_pk_add_f32 v[86:87], v[86:87], v[94:95]
    v_cvt_pk_bf16_f32 v116, v84, v85
    v_cvt_pk_bf16_f32 v117, v86, v87
    s_mov_b32 exec_hi, s56
    buffer_store_dwordx2 v[116:117], v5, s[32:35], s55 offen sc1
    s_mov_b32 exec_hi, -1
L_skip_18:
    s_cmp_eq_u32 s3, 1
    s_cbranch_scc0 L_skip_19
    v_add_u32 v113, 160000, v5
    ds_read_b64 v[64:65], v113 offset:0
    ds_read_b64 v[66:67], v113 offset:512
    ds_read_b64 v[68:69], v113 offset:1024
    ds_read_b64 v[70:71], v113 offset:1536
    ds_read_b64 v[72:73], v113 offset:2048
    s_lshl_b32 s50, s4, 12
    s_lshl_b32 s51, s5, 9
    s_add_u32 s50, s50, s51
    s_add_u32 s50, s50, 7340032
    s_waitcnt lgkmcnt(0)
    v_add3_u32 v114, v64, v66, s48
    v_add3_u32 v115, v65, v67, s48
    v_add3_u32 v68, v68, v70, v72
    v_add3_u32 v69, v69, v71, v73
    v_add_u32 v114, v114, v68
    v_add_u32 v115, v115, v69
    buffer_store_dwordx2 v[114:115], v5, s[32:35], s50 offen sc1
L_skip_19:
    ds_read_b64_tr_b16 v[128:129], v46 offset:0
    ds_read_b64_tr_b16 v[130:131], v47 offset:0
    ds_read_b64_tr_b16 v[132:133], v46 offset:8
    ds_read_b64_tr_b16 v[134:135], v47 offset:8
    ds_read_b64_tr_b16 v[136:137], v46 offset:16
    ds_read_b64_tr_b16 v[138:139], v47 offset:16
    ds_read_b64_tr_b16 v[140:141], v46 offset:24
    ds_read_b64_tr_b16 v[142:143], v47 offset:24
    ds_read_b64_tr_b16 v[144:145], v46 offset:32
    ds_read_b64_tr_b16 v[146:147], v47 offset:32
    ds_read_b64_tr_b16 v[148:149], v46 offset:20480
    ds_read_b64_tr_b16 v[150:151], v47 offset:20480
    ds_read_b64_tr_b16 v[152:153], v46 offset:20488
    ds_read_b64_tr_b16 v[154:155], v47 offset:20488
    ds_read_b64_tr_b16 v[156:157], v46 offset:20496
    s_waitcnt lgkmcnt(13)
    ds_read_b64_tr_b16 v[158:159], v47 offset:20496
    ds_read_b64_tr_b16 v[160:161], v46 offset:20504
    s_waitcnt lgkmcnt(13)
    ds_read_b64_tr_b16 v[162:163], v47 offset:20504
    ds_read_b64_tr_b16 v[164:165], v46 offset:20512
    s_waitcnt lgkmcnt(13)
    ds_read_b64_tr_b16 v[166:167], v47 offset:20512
    s_cmp_ge_u32 s3, 6
    s_cbranch_scc0 L_skip_22
    s_waitcnt vmcnt(0)
L_skip_22:
    s_barrier
    ds_read_b64_tr_b16 v[176:177], v46 offset:40960
    s_waitcnt lgkmcnt(13)
    ds_read_b64_tr_b16 v[178:179], v47 offset:40960
    ds_read_b64_tr_b16 v[180:181], v46 offset:40968
    s_waitcnt lgkmcnt(13)
    ds_read_b64_tr_b16 v[182:183], v47 offset:40968
    s_add_u32 s50, s53, 0
    buffer_load_dwordx4 v[64:67], v61, s[32:35], s50 offen sc1
    s_add_u32 s50, s53, 16384
    buffer_load_dwordx4 v[68:71], v61, s[32:35], s50 offen sc1
    s_add_u32 s50, s53, 32768
    buffer_load_dwordx4 v[72:75], v61, s[32:35], s50 offen sc1
    s_cmp_eq_u32 s3, 0
    s_cbranch_scc0 L_skip_23
    v_mov_b32 v242, s48
    s_lshl_b32 s50, s2, 5
    s_add_u32 s50, s50, 491520
    v_lshlrev_b32 v241, 24, v1
    s_waitcnt vmcnt(3)
    buffer_store_dword v242, v241, s[32:35], s50 offen sc1
    s_setprio 0
L_skip_23:
    ds_read_b64_tr_b16 v[184:185], v46 offset:40976
    s_waitcnt lgkmcnt(13)
    ds_read_b64_tr_b16 v[186:187], v47 offset:40976
    ds_read_b64_tr_b16 v[188:189], v46 offset:40984
    s_waitcnt lgkmcnt(13)
    ds_read_b64_tr_b16 v[190:191], v47 offset:40984
    ds_read_b64_tr_b16 v[192:193], v46 offset:40992
    s_waitcnt lgkmcnt(13)
    ds_read_b64_tr_b16 v[194:195], v47 offset:40992
    ds_read_b64_tr_b16 v[196:197], v48 offset:0
    s_waitcnt lgkmcnt(13)
    ds_read_b64_tr_b16 v[198:199], v49 offset:0
    ds_read_b64_tr_b16 v[200:201], v48 offset:8
    s_waitcnt lgkmcnt(13)
    ds_read_b64_tr_b16 v[202:203], v49 offset:8
    ds_read_b64_tr_b16 v[204:205], v48 offset:16
    s_waitcnt lgkmcnt(13)
    ds_read_b64_tr_b16 v[206:207], v49 offset:16
    ds_read_b64_tr_b16 v[208:209], v48 offset:24
    s_waitcnt lgkmcnt(13)
    ds_read_b64_tr_b16 v[210:211], v49 offset:24
    ds_read_b64_tr_b16 v[212:213], v48 offset:32
    s_waitcnt lgkmcnt(13)
    ds_read_b64_tr_b16 v[214:215], v49 offset:32
    ds_read_b64_tr_b16 v[216:217], v48 offset:20480
    s_waitcnt lgkmcnt(13)
    ds_read_b64_tr_b16 v[218:219], v49 offset:20480
    ds_read_b64_tr_b16 v[220:221], v48 offset:20488
    s_waitcnt lgkmcnt(13)
    ds_read_b64_tr_b16 v[222:223], v49 offset:20488
    ds_read_b64_tr_b16 v[224:225], v48 offset:20496
    s_waitcnt lgkmcnt(13)
    ds_read_b64_tr_b16 v[226:227], v49 offset:20496
    ds_read_b64_tr_b16 v[228:229], v48 offset:20504
    s_waitcnt lgkmcnt(13)
    ds_read_b64_tr_b16 v[230:231], v49 offset:20504
    ds_read_b64_tr_b16 v[232:233], v48 offset:20512
    s_waitcnt lgkmcnt(13)
    ds_read_b64_tr_b16 v[234:235], v49 offset:20512
    s_xor_b32 s50, s6, 1
    s_mul_i32 s50, s50, 3
    s_add_u32 s50, s50, s7
    s_mul_i32 s50, s50, 5120
    s_add_u32 s50, s50, 5120
    v_add_u32 v127, s50, v4
    s_mul_i32 s50, s6, 15360
    s_add_u32 s50, s50, 0
    v_add_u32 v63, s50, v4
    v_lshlrev_b32 v244, 5, v1
    s_waitcnt lgkmcnt(0)
    s_barrier
    s_waitcnt vmcnt(2)
    v_mfma_f32_16x16x32_bf16 v[104:107], v[128:131], v[64:67], 0
    v_mfma_f32_16x16x32_bf16 v[108:111], v[132:135], v[64:67], 0
    s_add_u32 s50, s53, 49152
    buffer_load_dwordx4 v[76:79], v61, s[32:35], s50 offen sc1
    v_mfma_f32_16x16x32_bf16 v[112:115], v[136:139], v[64:67], 0
    v_mfma_f32_16x16x32_bf16 v[116:119], v[140:143], v[64:67], 0
    v_add3_u32 v126, v64, v65, s57
    v_mfma_f32_16x16x32_bf16 v[120:123], v[144:147], v[64:67], 0
    v_add3_u32 v126, v126, v66, v67
    s_waitcnt vmcnt(2)
    v_mfma_f32_16x16x32_bf16 v[104:107], v[148:151], v[68:71], v[104:107]
    v_mfma_f32_16x16x32_bf16 v[108:111], v[152:155], v[68:71], v[108:111]
    s_add_u32 s50, s53, 65536
    buffer_load_dwordx4 v[80:83], v61, s[32:35], s50 offen sc1
    v_mfma_f32_16x16x32_bf16 v[112:115], v[156:159], v[68:71], v[112:115]
    s_add_u32 s50, s58, 0
    buffer_load_dwordx4 v[84:87], v61, s[32:35], s50 offen sc1
    v_mfma_f32_16x16x32_bf16 v[116:119], v[160:163], v[68:71], v[116:119]
    v_add3_u32 v126, v68, v69, v126
    v_mfma_f32_16x16x32_bf16 v[120:123], v[164:167], v[68:71], v[120:123]
    v_add3_u32 v126, v126, v70, v71
    s_waitcnt vmcnt(3)
    v_mfma_f32_16x16x32_bf16 v[104:107], v[176:179], v[72:75], v[104:107]
    v_mfma_f32_16x16x32_bf16 v[108:111], v[180:183], v[72:75], v[108:111]
    s_add_u32 s50, s58, 16384
    buffer_load_dwordx4 v[88:91], v61, s[32:35], s50 offen sc1
    v_mfma_f32_16x16x32_bf16 v[112:115], v[184:187], v[72:75], v[112:115]
    v_mfma_f32_16x16x32_bf16 v[116:119], v[188:191], v[72:75], v[116:119]
    v_add3_u32 v126, v72, v73, v126
    v_mfma_f32_16x16x32_bf16 v[120:123], v[192:195], v[72:75], v[120:123]
    v_add3_u32 v126, v126, v74, v75
    s_waitcnt vmcnt(3)
    v_mfma_f32_16x16x32_bf16 v[104:107], v[196:199], v[76:79], v[104:107]
    v_mfma_f32_16x16x32_bf16 v[108:111], v[200:203], v[76:79], v[108:111]
    s_add_u32 s50, s58, 32768
    buffer_load_dwordx4 v[92:95], v61, s[32:35], s50 offen sc1
    v_mfma_f32_16x16x32_bf16 v[112:115], v[204:207], v[76:79], v[112:115]
    s_add_u32 s50, s58, 49152
    buffer_load_dwordx4 v[96:99], v61, s[32:35], s50 offen sc1
    v_mfma_f32_16x16x32_bf16 v[116:119], v[208:211], v[76:79], v[116:119]
    v_add3_u32 v126, v76, v77, v126
    v_mfma_f32_16x16x32_bf16 v[120:123], v[212:215], v[76:79], v[120:123]
    v_add3_u32 v126, v126, v78, v79
    s_waitcnt vmcnt(4)
    v_mfma_f32_16x16x32_bf16 v[104:107], v[216:219], v[80:83], v[104:107]
    v_mfma_f32_16x16x32_bf16 v[108:111], v[220:223], v[80:83], v[108:111]
    s_add_u32 s50, s58, 65536
    buffer_load_dwordx4 v[100:103], v61, s[32:35], s50 offen sc1
    v_mfma_f32_16x16x32_bf16 v[112:115], v[224:227], v[80:83], v[112:115]
    v_mfma_f32_16x16x32_bf16 v[116:119], v[228:231], v[80:83], v[116:119]
    v_add3_u32 v126, v80, v81, v126
    v_mfma_f32_16x16x32_bf16 v[120:123], v[232:235], v[80:83], v[120:123]
    v_add3_u32 v126, v126, v82, v83
    s_waitcnt vmcnt(4)
    v_mfma_f32_16x16x32_bf16 v[8:11], v[128:131], v[84:87], 0
    buffer_load_dword v124, v50, s[32:35], s59 offen offset:0 sc1
    v_mfma_f32_16x16x32_bf16 v[12:15], v[132:135], v[84:87], 0
    buffer_load_dword v125, v50, s[32:35], s59 offen offset:1024 sc1
    v_add3_u32 v126, v84, v85, v126
    v_mfma_f32_16x16x32_bf16 v[16:19], v[136:139], v[84:87], 0
    v_add3_u32 v126, v126, v86, v87
    v_mfma_f32_16x16x32_bf16 v[20:23], v[140:143], v[84:87], 0
    v_mfma_f32_16x16x32_bf16 v[24:27], v[144:147], v[84:87], 0
    ds_write_b128 v127, v[104:107] offset:0
    ds_write_b128 v127, v[108:111] offset:1024
    s_waitcnt vmcnt(5)
    v_mfma_f32_16x16x32_bf16 v[8:11], v[148:151], v[88:91], v[8:11]
    v_add3_u32 v126, v88, v89, v126
    v_mfma_f32_16x16x32_bf16 v[12:15], v[152:155], v[88:91], v[12:15]
    v_add3_u32 v126, v126, v90, v91
    v_mfma_f32_16x16x32_bf16 v[16:19], v[156:159], v[88:91], v[16:19]
    ds_write_b128 v127, v[112:115] offset:2048
    v_mfma_f32_16x16x32_bf16 v[20:23], v[160:163], v[88:91], v[20:23]
    ds_write_b128 v127, v[116:119] offset:3072
    v_mfma_f32_16x16x32_bf16 v[24:27], v[164:167], v[88:91], v[24:27]
    ds_write_b128 v127, v[120:123] offset:4096
    s_waitcnt vmcnt(0)
    v_add3_u32 v126, v92, v93, v126
    v_add3_u32 v126, v126, v94, v95
    v_add3_u32 v126, v96, v97, v126
    v_add3_u32 v126, v126, v98, v99
    v_add3_u32 v126, v100, v101, v126
    v_add3_u32 v126, v126, v102, v103
    v_add_u32 v124, v124, v125
    v_cmp_ne_u32 vcc, v126, v124
    s_cbranch_vccnz L_hretry
L_hback:
    s_cmp_lt_u32 s3, 4
    s_cbranch_scc0 L_qyoung_20
    s_cmp_eq_u32 s3, 0
    s_cbranch_scc0 L_skip_24
    s_mov_b32 s50, 491520
    buffer_load_dword v240, v244, s[32:35], s50 offen sc1
    s_mov_b32 s50, 493568
    buffer_load_dword v241, v244, s[32:35], s50 offen sc1
    s_mov_b32 s50, 495616
    buffer_load_dword v242, v244, s[32:35], s50 offen sc1
    s_mov_b32 s50, 497664
    buffer_load_dword v243, v244, s[32:35], s50 offen sc1
L_skip_24:
    v_mfma_f32_16x16x32_bf16 v[8:11], v[176:179], v[92:95], v[8:11]
    v_mfma_f32_16x16x32_bf16 v[12:15], v[180:183], v[92:95], v[12:15]
    v_mfma_f32_16x16x32_bf16 v[16:19], v[184:187], v[92:95], v[16:19]
    v_mfma_f32_16x16x32_bf16 v[20:23], v[188:191], v[92:95], v[20:23]
    v_mfma_f32_16x16x32_bf16 v[24:27], v[192:195], v[92:95], v[24:27]
    v_mfma_f32_16x16x32_bf16 v[8:11], v[196:199], v[96:99], v[8:11]
    v_mfma_f32_16x16x32_bf16 v[12:15], v[200:203], v[96:99], v[12:15]
    v_mfma_f32_16x16x32_bf16 v[16:19], v[204:207], v[96:99], v[16:19]
    v_mfma_f32_16x16x32_bf16 v[20:23], v[208:211], v[96:99], v[20:23]
    v_mfma_f32_16x16x32_bf16 v[24:27], v[212:215], v[96:99], v[24:27]
    s_waitcnt lgkmcnt(0)
    s_barrier
    v_mfma_f32_16x16x32_bf16 v[8:11], v[216:219], v[100:103], v[8:11]
    v_mfma_f32_16x16x32_bf16 v[12:15], v[220:223], v[100:103], v[12:15]
    v_mfma_f32_16x16x32_bf16 v[16:19], v[224:227], v[100:103], v[16:19]
    v_mfma_f32_16x16x32_bf16 v[20:23], v[228:231], v[100:103], v[20:23]
    v_mfma_f32_16x16x32_bf16 v[24:27], v[232:235], v[100:103], v[24:27]
    s_nop 3
    ds_write_b128 v63, v[8:11] offset:0
    ds_write_b128 v63, v[12:15] offset:1024
    ds_write_b128 v63, v[16:19] offset:2048
    ds_write_b128 v63, v[20:23] offset:3072
    ds_write_b128 v63, v[24:27] offset:4096
    s_cmp_eq_u32 s3, 0
    s_cbranch_scc0 L_skip_25
    s_waitcnt vmcnt(0)
    v_xor_b32 v240, s48, v240
    v_xor_b32 v241, s48, v241
    v_xor_b32 v242, s48, v242
    v_xor_b32 v243, s48, v243
    v_or3_b32 v240, v240, v241, v242
    v_or_b32 v240, v240, v243
    v_cmp_ne_u32 vcc, 0, v240
    s_cbranch_vccnz L_h2retry
L_h2ok:
L_skip_25:
    s_waitcnt lgkmcnt(0)
    s_barrier
    buffer_load_dwordx2 v[164:165], v5, s[32:35], s60 offen offset:2560 sc1
    buffer_load_dwordx4 v[128:131], v4, s[32:35], s60 offen sc1
    buffer_load_dwordx4 v[140:143], v6, s[32:35], s60 offen offset:1024 sc1
    buffer_load_dwordx4 v[144:147], v6, s[32:35], s60 offen offset:1792 sc1
    v_mov_b32 v182, 0
    v_mov_b32 v183, 0
    s_nop 1
    v_mfma_f32_32x32x4_2b_bf16 v[64:95], v[182:183], v[182:183], 0
    v_mfma_f32_32x32x4_2b_bf16 v[96:127], v[182:183], v[182:183], 0
    s_barrier
    s_branch L_qdone_21
L_qyoung_20:
    s_waitcnt lgkmcnt(0)
    s_barrier
    v_mfma_f32_16x16x32_bf16 v[8:11], v[176:179], v[92:95], v[8:11]
    ds_read_b128 v[64:67], v63 offset:5120
    ds_read_b128 v[68:71], v63 offset:6144
    v_mfma_f32_16x16x32_bf16 v[12:15], v[180:183], v[92:95], v[12:15]
    ds_read_b128 v[72:75], v63 offset:7168
    ds_read_b128 v[76:79], v63 offset:8192
    v_mfma_f32_16x16x32_bf16 v[16:19], v[184:187], v[92:95], v[16:19]
    ds_read_b128 v[80:83], v63 offset:9216
    ds_read_b128 v[104:107], v63 offset:10240
    v_mfma_f32_16x16x32_bf16 v[20:23], v[188:191], v[92:95], v[20:23]
    ds_read_b128 v[108:111], v63 offset:11264
    ds_read_b128 v[112:115], v63 offset:12288
    v_mfma_f32_16x16x32_bf16 v[24:27], v[192:195], v[92:95], v[24:27]
    ds_read_b128 v[116:119], v63 offset:13312
    ds_read_b128 v[120:123], v63 offset:14336
    v_mfma_f32_16x16x32_bf16 v[8:11], v[196:199], v[96:99], v[8:11]
    v_mfma_f32_16x16x32_bf16 v[12:15], v[200:203], v[96:99], v[12:15]
    v_mfma_f32_16x16x32_bf16 v[16:19], v[204:207], v[96:99], v[16:19]
    v_mfma_f32_16x16x32_bf16 v[20:23], v[208:211], v[96:99], v[20:23]
    v_mfma_f32_16x16x32_bf16 v[24:27], v[212:215], v[96:99], v[24:27]
    s_waitcnt lgkmcnt(0)
    v_mfma_f32_16x16x32_bf16 v[8:11], v[216:219], v[100:103], v[8:11]
    v_pk_add_f32 v[64:65], v[64:65], v[104:105]
    v_pk_add_f32 v[66:67], v[66:67], v[106:107]
    v_mfma_f32_16x16x32_bf16 v[12:15], v[220:223], v[100:103], v[12:15]
    v_pk_add_f32 v[68:69], v[68:69], v[108:109]
    v_pk_add_f32 v[70:71], v[70:71], v[110:111]
    v_mfma_f32_16x16x32_bf16 v[16:19], v[224:227], v[100:103], v[16:19]
    v_pk_add_f32 v[72:73], v[72:73], v[112:113]
    v_pk_add_f32 v[74:75], v[74:75], v[114:115]
    v_mfma_f32_16x16x32_bf16 v[20:23], v[228:231], v[100:103], v[20:23]
    v_pk_add_f32 v[76:77], v[76:77], v[116:117]
    v_pk_add_f32 v[78:79], v[78:79], v[118:119]
    v_mfma_f32_16x16x32_bf16 v[24:27], v[232:235], v[100:103], v[24:27]
    v_pk_add_f32 v[80:81], v[80:81], v[120:121]
    v_pk_add_f32 v[82:83], v[82:83], v[122:123]
    v_pk_add_f32 v[8:9], v[8:9], v[64:65]
    v_pk_add_f32 v[10:11], v[10:11], v[66:67]
    v_pk_add_f32 v[12:13], v[12:13], v[68:69]
    v_pk_add_f32 v[14:15], v[14:15], v[70:71]
    v_pk_add_f32 v[16:17], v[16:17], v[72:73]
    v_pk_add_f32 v[18:19], v[18:19], v[74:75]
    v_pk_add_f32 v[20:21], v[20:21], v[76:77]
    v_pk_add_f32 v[22:23], v[22:23], v[78:79]
    v_pk_add_f32 v[24:25], v[24:25], v[80:81]
    v_pk_add_f32 v[26:27], v[26:27], v[82:83]
    s_barrier
    ds_read_b128 v[236:239], v63 offset:0
    ds_read_b128 v[240:243], v63 offset:1024
    ds_read_b128 v[244:247], v63 offset:2048
    ds_read_b128 v[248:251], v63 offset:3072
    ds_read_b128 v[252:255], v63 offset:4096
    s_waitcnt lgkmcnt(4)
    v_pk_add_f32 v[8:9], v[8:9], v[236:237]
    v_pk_add_f32 v[10:11], v[10:11], v[238:239]
    v_cvt_pk_bf16_f32 v192, v8, v9
    v_cvt_pk_bf16_f32 v193, v10, v11
    s_waitcnt lgkmcnt(3)
    v_pk_add_f32 v[12:13], v[12:13], v[240:241]
    v_pk_add_f32 v[14:15], v[14:15], v[242:243]
    v_cvt_pk_bf16_f32 v194, v12, v13
    v_cvt_pk_bf16_f32 v195, v14, v15
    s_waitcnt lgkmcnt(2)
    v_pk_add_f32 v[16:17], v[16:17], v[244:245]
    v_pk_add_f32 v[18:19], v[18:19], v[246:247]
    v_cvt_pk_bf16_f32 v196, v16, v17
    v_cvt_pk_bf16_f32 v197, v18, v19
    s_waitcnt lgkmcnt(1)
    v_pk_add_f32 v[20:21], v[20:21], v[248:249]
    v_pk_add_f32 v[22:23], v[22:23], v[250:251]
    v_cvt_pk_bf16_f32 v198, v20, v21
    v_cvt_pk_bf16_f32 v199, v22, v23
    s_waitcnt lgkmcnt(0)
    v_pk_add_f32 v[24:25], v[24:25], v[252:253]
    v_pk_add_f32 v[26:27], v[26:27], v[254:255]
    v_cvt_pk_bf16_f32 v200, v24, v25
    v_cvt_pk_bf16_f32 v201, v26, v27
    ds_write_b128 v51, v[192:195]
    ds_write_b128 v51, v[196:199] offset:16
    ds_write_b64 v51, v[200:201] offset:32
    s_waitcnt lgkmcnt(0)
    s_barrier
    buffer_load_dwordx2 v[164:165], v5, s[32:35], s60 offen offset:2560 sc1
    buffer_load_dwordx4 v[128:131], v4, s[32:35], s60 offen sc1
    buffer_load_dwordx4 v[140:143], v6, s[32:35], s60 offen offset:1024 sc1
    buffer_load_dwordx4 v[144:147], v6, s[32:35], s60 offen offset:1792 sc1
    v_mov_b32 v182, 0
    v_mov_b32 v183, 0
    s_nop 1
    v_mfma_f32_32x32x4_2b_bf16 v[64:95], v[182:183], v[182:183], 0
    v_mfma_f32_32x32x4_2b_bf16 v[96:127], v[182:183], v[182:183], 0
L_qdone_21:
    s_setprio 3
    ds_read_b64 v[24:25], v32 offset:32
    ds_read_b64 v[26:27], v33 offset:32
    ds_read_b128 v[8:11], v28
    ds_read_b128 v[12:15], v29
    ds_read_b128 v[16:19], v30
    ds_read_b128 v[20:23], v31
    buffer_load_dwordx4 v[132:135], v4, s[32:35], s61 offen sc1
    s_waitcnt vmcnt(3)
    s_waitcnt lgkmcnt(4)
    v_mfma_f32_32x32x4_2b_bf16 v[192:223], v[164:165], v[24:25], 0 cbsz:1 abid:0
    buffer_load_dwordx4 v[148:151], v6, s[32:35], s61 offen offset:1024 sc1
    buffer_load_dwordx4 v[152:155], v6, s[32:35], s61 offen offset:1792 sc1
    s_waitcnt lgkmcnt(0)
    s_nop 14
    v_mfma_f32_32x32x16_bf16 v[192:207], v[128:131], v[8:11], v[192:207]
    v_mfma_f32_32x32x16_bf16 v[208:223], v[128:131], v[12:15], v[208:223]
    s_nop 10
    v_exp_f32 v192, v192
    v_exp_f32 v193, v193
    buffer_load_dwordx2 v[166:167], v5, s[32:35], s62 offen offset:2560 sc1
    buffer_load_dwordx4 v[136:139], v4, s[32:35], s62 offen sc1
    v_exp_f32 v194, v194
    v_exp_f32 v195, v195
    v_exp_f32 v196, v196
    v_mfma_f32_32x32x4_2b_bf16 v[224:255], v[164:165], v[26:27], 0 cbsz:1 abid:0
    buffer_load_dwordx4 v[156:159], v6, s[32:35], s62 offen offset:1024 sc1
    buffer_load_dwordx4 v[160:163], v6, s[32:35], s62 offen offset:1792 sc1
    v_exp_f32 v197, v197
    v_exp_f32 v198, v198
    v_exp_f32 v199, v199
    v_exp_f32 v200, v200
    v_exp_f32 v201, v201
    v_exp_f32 v202, v202
    v_exp_f32 v203, v203
    v_exp_f32 v204, v204
    s_waitcnt vmcnt(7)
    v_smfmac_f32_32x32x32_bf16 v[64:79], v[140:143], v[192:199], v7
    v_exp_f32 v205, v205
    v_exp_f32 v206, v206
    v_exp_f32 v207, v207
    v_exp_f32 v208, v208
    v_exp_f32 v209, v209
    v_smfmac_f32_32x32x32_bf16 v[64:79], v[144:147], v[200:207], v7
    s_mov_b32 exec_lo, s79
    s_mov_b32 exec_hi, s79
    buffer_load_dwordx4 v[28:31], v55, s[24:27], s83 offen nt
    s_mov_b64 exec, -1
    s_add_u32 s83, s83, 491520
    v_exp_f32 v210, v210
    v_exp_f32 v211, v211
    v_exp_f32 v212, v212
    v_mfma_f32_32x32x16_bf16 v[224:239], v[128:131], v[16:19], v[224:239]
    v_exp_f32 v213, v213
    v_exp_f32 v214, v214
    v_exp_f32 v215, v215
    v_exp_f32 v216, v216
    v_mfma_f32_32x32x16_bf16 v[240:255], v[128:131], v[20:23], v[240:255]
    v_exp_f32 v217, v217
    v_exp_f32 v218, v218
    v_exp_f32 v219, v219
    v_smfmac_f32_32x32x32_bf16 v[80:95], v[140:143], v[208:215], v7
    v_exp_f32 v220, v220
    v_exp_f32 v221, v221
    v_exp_f32 v222, v222
    v_exp_f32 v223, v223
    v_exp_f32 v224, v224
    v_exp_f32 v225, v225
    v_smfmac_f32_32x32x32_bf16 v[80:95], v[144:147], v[216:223], v7
    s_waitcnt vmcnt(7)
    v_exp_f32 v226, v226
    v_exp_f32 v227, v227
    v_exp_f32 v228, v228
    v_mfma_f32_32x32x4_2b_bf16 v[192:223], v[164:165], v[24:25], 0 cbsz:1 abid:1
    buffer_load_dwordx4 v[128:131], v4, s[32:35], s63 offen sc1
    v_exp_f32 v229, v229
    v_exp_f32 v230, v230
    v_exp_f32 v231, v231
    v_exp_f32 v232, v232
    v_exp_f32 v233, v233
    v_exp_f32 v234, v234
    v_exp_f32 v235, v235
    v_exp_f32 v236, v236
    v_smfmac_f32_32x32x32_bf16 v[96:111], v[140:143], v[224:231], v7
    v_exp_f32 v237, v237
    v_exp_f32 v238, v238
    v_exp_f32 v239, v239
    v_exp_f32 v240, v240
    v_exp_f32 v241, v241
    v_smfmac_f32_32x32x32_bf16 v[96:111], v[144:147], v[232:239], v7
    v_mov_b32 v176, -1
    v_mov_b32 v177, -1
    v_mov_b32 v178, -1
    v_mov_b32 v179, -1
    buffer_store_dwordx4 v[176:179], v174, s[32:35], s80 offen sc1
    buffer_store_dword v176, v175, s[32:35], s80 offen sc1
    s_mov_b32 exec_lo, s79
    s_mov_b32 exec_hi, s79
    buffer_load_dwordx4 v[46:49], v55, s[24:27], s83 offen nt
    s_mov_b64 exec, -1
    s_sub_u32 s50, s7, 1
    s_and_b32 s50, s50, 491520
    s_add_u32 s83, s83, s50
    v_exp_f32 v242, v242
    v_exp_f32 v243, v243
    v_exp_f32 v244, v244
    v_mfma_f32_32x32x16_bf16 v[192:207], v[132:135], v[8:11], v[192:207]
    v_exp_f32 v245, v245
    v_exp_f32 v246, v246
    v_exp_f32 v247, v247
    v_exp_f32 v248, v248
    v_mfma_f32_32x32x16_bf16 v[208:223], v[132:135], v[12:15], v[208:223]
    v_exp_f32 v249, v249
    v_exp_f32 v250, v250
    v_exp_f32 v251, v251
    v_smfmac_f32_32x32x32_bf16 v[112:127], v[140:143], v[240:247], v7
    v_exp_f32 v252, v252
    v_exp_f32 v253, v253
    v_exp_f32 v254, v254
    v_exp_f32 v255, v255
    v_exp_f32 v192, v192
    v_exp_f32 v193, v193
    v_smfmac_f32_32x32x32_bf16 v[112:127], v[144:147], v[248:255], v7
    buffer_load_dwordx4 v[140:143], v6, s[32:35], s63 offen offset:1024 sc1
    buffer_load_dwordx4 v[144:147], v6, s[32:35], s63 offen offset:1792 sc1
    v_exp_f32 v194, v194
    v_exp_f32 v195, v195
    v_exp_f32 v196, v196
    v_mfma_f32_32x32x4_2b_bf16 v[224:255], v[164:165], v[26:27], 0 cbsz:1 abid:1
    v_exp_f32 v197, v197
    v_exp_f32 v198, v198
    v_exp_f32 v199, v199
    v_exp_f32 v200, v200
    v_exp_f32 v201, v201
    v_exp_f32 v202, v202
    v_exp_f32 v203, v203
    v_exp_f32 v204, v204
    s_waitcnt vmcnt(11)
    v_smfmac_f32_32x32x32_bf16 v[64:79], v[148:151], v[192:199], v7
    v_exp_f32 v205, v205
    v_exp_f32 v206, v206
    v_exp_f32 v207, v207
    v_exp_f32 v208, v208
    v_exp_f32 v209, v209
    v_smfmac_f32_32x32x32_bf16 v[64:79], v[152:155], v[200:207], v7
    s_mov_b32 exec_lo, s79
    s_mov_b32 exec_hi, s79
    buffer_load_dwordx4 v[188:191], v55, s[24:27], s83 offen nt
    s_mov_b64 exec, -1
    v_exp_f32 v210, v210
    v_exp_f32 v211, v211
    v_exp_f32 v212, v212
    v_mfma_f32_32x32x16_bf16 v[224:239], v[132:135], v[16:19], v[224:239]
    v_exp_f32 v213, v213
    v_exp_f32 v214, v214
    v_exp_f32 v215, v215
    v_exp_f32 v216, v216
    v_mfma_f32_32x32x16_bf16 v[240:255], v[132:135], v[20:23], v[240:255]
    v_exp_f32 v217, v217
    v_exp_f32 v218, v218
    v_exp_f32 v219, v219
    v_smfmac_f32_32x32x32_bf16 v[80:95], v[148:151], v[208:215], v7
    v_exp_f32 v220, v220
    v_exp_f32 v221, v221
    v_exp_f32 v222, v222
    v_exp_f32 v223, v223
    v_exp_f32 v224, v224
    v_exp_f32 v225, v225
    v_smfmac_f32_32x32x32_bf16 v[80:95], v[152:155], v[216:223], v7
    s_waitcnt vmcnt(10)
    v_exp_f32 v226, v226
    v_exp_f32 v227, v227
    v_exp_f32 v228, v228
    v_mfma_f32_32x32x4_2b_bf16 v[192:223], v[166:167], v[24:25], 0 cbsz:1 abid:0
    buffer_load_dwordx4 v[132:135], v4, s[32:35], s64 offen sc1
    buffer_load_dwordx2 v[164:165], v5, s[32:35], s64 offen offset:2560 sc1
    v_exp_f32 v229, v229
    v_exp_f32 v230, v230
    v_exp_f32 v231, v231
    v_exp_f32 v232, v232
    v_exp_f32 v233, v233
    v_exp_f32 v234, v234
    v_exp_f32 v235, v235
    v_exp_f32 v236, v236
    v_smfmac_f32_32x32x32_bf16 v[96:111], v[148:151], v[224:231], v7
    v_exp_f32 v237, v237
    v_exp_f32 v238, v238
    v_exp_f32 v239, v239
    v_exp_f32 v240, v240
    v_exp_f32 v241, v241
    v_smfmac_f32_32x32x32_bf16 v[96:111], v[152:155], v[232:239], v7
    v_exp_f32 v242, v242
    v_exp_f32 v243, v243
    v_exp_f32 v244, v244
    v_mfma_f32_32x32x16_bf16 v[192:207], v[136:139], v[8:11], v[192:207]
    v_exp_f32 v245, v245
    v_exp_f32 v246, v246
    v_exp_f32 v247, v247
    v_exp_f32 v248, v248
    v_mfma_f32_32x32x16_bf16 v[208:223], v[136:139], v[12:15], v[208:223]
    v_lshlrev_b32 v186, 7, v1
    s_lshl_b32 s50, s2, 3
    s_add_u32 s50, s50, s3
    s_lshr_b32 s50, s50, 0
    s_mul_i32 s50, s50, 400
    s_andn2_b32 s50, s50, 127
    s_mov_b64 exec, 15
    buffer_load_dword v185, v186, s[20:23], s50 offen offset:0
    s_mov_b64 exec, -1
    v_exp_f32 v249, v249
    v_exp_f32 v250, v250
    v_exp_f32 v251, v251
    v_smfmac_f32_32x32x32_bf16 v[112:127], v[148:151], v[240:247], v7
    v_exp_f32 v252, v252
    v_exp_f32 v253, v253
    v_exp_f32 v254, v254
    v_exp_f32 v255, v255
    v_exp_f32 v192, v192
    v_exp_f32 v193, v193
    v_smfmac_f32_32x32x32_bf16 v[112:127], v[152:155], v[248:255], v7
    buffer_load_dwordx4 v[148:151], v6, s[32:35], s64 offen offset:1024 sc1
    buffer_load_dwordx4 v[152:155], v6, s[32:35], s64 offen offset:1792 sc1
    v_exp_f32 v194, v194
    v_exp_f32 v195, v195
    v_exp_f32 v196, v196
    v_mfma_f32_32x32x4_2b_bf16 v[224:255], v[166:167], v[26:27], 0 cbsz:1 abid:0
    v_exp_f32 v197, v197
    v_exp_f32 v198, v198
    v_exp_f32 v199, v199
    v_exp_f32 v200, v200
    v_exp_f32 v201, v201
    v_exp_f32 v202, v202
    v_exp_f32 v203, v203
    v_exp_f32 v204, v204
    s_waitcnt vmcnt(13)
    v_smfmac_f32_32x32x32_bf16 v[64:79], v[156:159], v[192:199], v7
    v_exp_f32 v205, v205
    v_exp_f32 v206, v206
    v_exp_f32 v207, v207
    v_exp_f32 v208, v208
    v_exp_f32 v209, v209
    v_smfmac_f32_32x32x32_bf16 v[64:79], v[160:163], v[200:207], v7
    v_exp_f32 v210, v210
    v_exp_f32 v211, v211
    v_exp_f32 v212, v212
    v_mfma_f32_32x32x16_bf16 v[224:239], v[136:139], v[16:19], v[224:239]
    v_exp_f32 v213, v213
    v_exp_f32 v214, v214
    v_exp_f32 v215, v215
    v_exp_f32 v216, v216
    v_mfma_f32_32x32x16_bf16 v[240:255], v[136:139], v[20:23], v[240:255]
    s_lshl_b32 s50, s2, 3
    s_add_u32 s50, s50, s3
    s_lshr_b32 s50, s50, 1
    s_mul_i32 s50, s50, 2160
    s_andn2_b32 s50, s50, 127
    s_mov_b64 exec, 511
    buffer_load_dword v185, v186, s[28:31], s50 offen offset:0
    s_mov_b64 exec, -1
    v_exp_f32 v217, v217
    v_exp_f32 v218, v218
    v_exp_f32 v219, v219
    v_smfmac_f32_32x32x32_bf16 v[80:95], v[156:159], v[208:215], v7
    v_exp_f32 v220, v220
    v_exp_f32 v221, v221
    v_exp_f32 v222, v222
    v_exp_f32 v223, v223
    v_exp_f32 v224, v224
    v_exp_f32 v225, v225
    v_smfmac_f32_32x32x32_bf16 v[80:95], v[160:163], v[216:223], v7
    s_waitcnt vmcnt(12)
    v_exp_f32 v226, v226
    v_exp_f32 v227, v227
    v_exp_f32 v228, v228
    v_mfma_f32_32x32x4_2b_bf16 v[192:223], v[166:167], v[24:25], 0 cbsz:1 abid:1
    buffer_load_dwordx4 v[136:139], v4, s[32:35], s65 offen sc1
    v_exp_f32 v229, v229
    v_exp_f32 v230, v230
    v_exp_f32 v231, v231
    v_exp_f32 v232, v232
    v_exp_f32 v233, v233
    v_exp_f32 v234, v234
    v_exp_f32 v235, v235
    v_exp_f32 v236, v236
    v_smfmac_f32_32x32x32_bf16 v[96:111], v[156:159], v[224:231], v7
    v_exp_f32 v237, v237
    v_exp_f32 v238, v238
    v_exp_f32 v239, v239
    v_exp_f32 v240, v240
    v_exp_f32 v241, v241
    v_smfmac_f32_32x32x32_bf16 v[96:111], v[160:163], v[232:239], v7
    v_exp_f32 v242, v242
    v_exp_f32 v243, v243
    v_exp_f32 v244, v244
    v_mfma_f32_32x32x16_bf16 v[192:207], v[128:131], v[8:11], v[192:207]
    v_exp_f32 v245, v245
    v_exp_f32 v246, v246
    v_exp_f32 v247, v247
    v_exp_f32 v248, v248
    v_mfma_f32_32x32x16_bf16 v[208:223], v[128:131], v[12:15], v[208:223]
    s_lshl_b32 s50, s2, 3
    s_add_u32 s50, s50, s3
    s_lshr_b32 s50, s50, 1
    s_mul_i32 s50, s50, 2160
    s_andn2_b32 s50, s50, 127
    s_mov_b64 exec, 511
    buffer_load_dword v185, v186, s[28:31], s50 offen offset:1152
    s_mov_b64 exec, -1
    v_exp_f32 v249, v249
    v_exp_f32 v250, v250
    v_exp_f32 v251, v251
    v_smfmac_f32_32x32x32_bf16 v[112:127], v[156:159], v[240:247], v7
    v_exp_f32 v252, v252
    v_exp_f32 v253, v253
    v_exp_f32 v254, v254
    v_exp_f32 v255, v255
    v_exp_f32 v192, v192
    v_exp_f32 v193, v193
    v_smfmac_f32_32x32x32_bf16 v[112:127], v[160:163], v[248:255], v7
    buffer_load_dwordx4 v[156:159], v6, s[32:35], s65 offen offset:1024 sc1
    buffer_load_dwordx4 v[160:163], v6, s[32:35], s65 offen offset:1792 sc1
    v_exp_f32 v194, v194
    v_exp_f32 v195, v195
    v_exp_f32 v196, v196
    v_mfma_f32_32x32x4_2b_bf16 v[224:255], v[166:167], v[26:27], 0 cbsz:1 abid:1
    v_exp_f32 v197, v197
    v_exp_f32 v198, v198
    v_exp_f32 v199, v199
    v_exp_f32 v200, v200
    v_exp_f32 v201, v201
    v_exp_f32 v202, v202
    v_exp_f32 v203, v203
    v_exp_f32 v204, v204
    s_waitcnt vmcnt(11)
    v_smfmac_f32_32x32x32_bf16 v[64:79], v[140:143], v[192:199], v7
    v_exp_f32 v205, v205
    v_exp_f32 v206, v206
    v_exp_f32 v207, v207
    v_exp_f32 v208, v208
    v_exp_f32 v209, v209
    v_smfmac_f32_32x32x32_bf16 v[64:79], v[144:147], v[200:207], v7
    v_exp_f32 v210, v210
    v_exp_f32 v211, v211
    v_exp_f32 v212, v212
    v_mfma_f32_32x32x16_bf16 v[224:239], v[128:131], v[16:19], v[224:239]
    v_exp_f32 v213, v213
    v_exp_f32 v214, v214
    v_exp_f32 v215, v215
    v_exp_f32 v216, v216
    v_mfma_f32_32x32x16_bf16 v[240:255], v[128:131], v[20:23], v[240:255]
    s_lshl_b32 s50, s2, 3
    s_add_u32 s50, s50, s3
    s_lshr_b32 s50, s50, 0
    s_mul_i32 s50, s50, 1080
    s_andn2_b32 s50, s50, 127
    s_mov_b64 exec, 511
    buffer_load_dword v185, v186, s[96:99], s50 offen offset:0
    s_mov_b64 exec, -1
    v_exp_f32 v217, v217
    v_exp_f32 v218, v218
    v_exp_f32 v219, v219
    v_smfmac_f32_32x32x32_bf16 v[80:95], v[140:143], v[208:215], v7
    v_exp_f32 v220, v220
    v_exp_f32 v221, v221
    v_exp_f32 v222, v222
    v_exp_f32 v223, v223
    v_exp_f32 v224, v224
    v_exp_f32 v225, v225
    v_smfmac_f32_32x32x32_bf16 v[80:95], v[144:147], v[216:223], v7
    s_waitcnt vmcnt(9)
    v_exp_f32 v226, v226
    v_exp_f32 v227, v227
    v_exp_f32 v228, v228
    v_mfma_f32_32x32x4_2b_bf16 v[192:223], v[164:165], v[24:25], 0 cbsz:1 abid:0
    buffer_load_dwordx4 v[128:131], v4, s[32:35], s66 offen sc1
    buffer_load_dwordx2 v[166:167], v5, s[32:35], s66 offen offset:2560 sc1
    v_exp_f32 v229, v229
    v_exp_f32 v230, v230
    v_exp_f32 v231, v231
    v_exp_f32 v232, v232
    v_exp_f32 v233, v233
    v_exp_f32 v234, v234
    v_exp_f32 v235, v235
    v_exp_f32 v236, v236
    v_smfmac_f32_32x32x32_bf16 v[96:111], v[140:143], v[224:231], v7
    v_exp_f32 v237, v237
    v_exp_f32 v238, v238
    v_exp_f32 v239, v239
    v_exp_f32 v240, v240
    v_exp_f32 v241, v241
    v_smfmac_f32_32x32x32_bf16 v[96:111], v[144:147], v[232:239], v7
    s_lshl_b32 s58, s4, 8
    s_add_u32 s58, s58, 180224
    s_lshl_b32 s50, s5, 5
    s_lshl_b32 s51, s3, 2
    s_add_u32 s50, s50, s51
    s_add_u32 s50, s50, s58
    v_mov_b32 v180, s91
    s_mov_b64 exec, 1
    buffer_store_dword v180, v4, s[32:35], s50 offen sc1
    s_mov_b64 exec, -1
    v_mfma_f32_16x16x32_bf16 v[50:53], v[34:37], v[28:31], 0
    v_mfma_f32_16x16x32_bf16 v[50:53], v[38:41], v[46:49], v[50:53]
    v_mfma_f32_16x16x32_bf16 v[50:53], v[42:45], v[188:191], v[50:53]
    s_lshl_b32 s50, s3, 2
    s_add_u32 s50, s50, 163072
    v_mov_b32 v63, s50
    v_exp_f32 v242, v242
    v_exp_f32 v243, v243
    v_exp_f32 v244, v244
    v_mfma_f32_32x32x16_bf16 v[192:207], v[132:135], v[8:11], v[192:207]
    v_exp_f32 v245, v245
    v_exp_f32 v246, v246
    v_exp_f32 v247, v247
    v_exp_f32 v248, v248
    v_mfma_f32_32x32x16_bf16 v[208:223], v[132:135], v[12:15], v[208:223]
    s_mov_b32 exec_lo, 0x00ff00ff
    s_mov_b32 exec_hi, 0xff00ff00
    ds_write_b128 v54, v[50:53]
    s_mov_b64 exec, 1
    ds_write_b32 v63, v7
    s_mov_b64 exec, -1
    v_exp_f32 v249, v249
    v_exp_f32 v250, v250
    v_exp_f32 v251, v251
    v_smfmac_f32_32x32x32_bf16 v[112:127], v[140:143], v[240:247], v7
    v_exp_f32 v252, v252
    v_exp_f32 v253, v253
    v_exp_f32 v254, v254
    v_exp_f32 v255, v255
    s_setprio 2
    v_exp_f32 v192, v192
    v_exp_f32 v193, v193
    v_smfmac_f32_32x32x32_bf16 v[112:127], v[144:147], v[248:255], v7
    buffer_load_dwordx4 v[140:143], v6, s[32:35], s66 offen offset:1024 sc1
    buffer_load_dwordx4 v[144:147], v6, s[32:35], s66 offen offset:1792 sc1
    v_exp_f32 v194, v194
    v_exp_f32 v195, v195
    v_exp_f32 v196, v196
    v_mfma_f32_32x32x4_2b_bf16 v[224:255], v[164:165], v[26:27], 0 cbsz:1 abid:0
    v_exp_f32 v197, v197
    v_exp_f32 v198, v198
    v_exp_f32 v199, v199
    v_exp_f32 v200, v200
    v_exp_f32 v201, v201
    v_exp_f32 v202, v202
    v_exp_f32 v203, v203
    v_exp_f32 v204, v204
    s_waitcnt vmcnt(11)
    v_smfmac_f32_32x32x32_bf16 v[64:79], v[148:151], v[192:199], v7
    v_exp_f32 v205, v205
    v_exp_f32 v206, v206
    v_exp_f32 v207, v207
    v_exp_f32 v208, v208
    v_exp_f32 v209, v209
    v_smfmac_f32_32x32x32_bf16 v[64:79], v[152:155], v[200:207], v7
    v_exp_f32 v210, v210
    v_exp_f32 v211, v211
    v_exp_f32 v212, v212
    v_mfma_f32_32x32x16_bf16 v[224:239], v[132:135], v[16:19], v[224:239]
    v_exp_f32 v213, v213
    v_exp_f32 v214, v214
    v_exp_f32 v215, v215
    v_exp_f32 v216, v216
    v_mfma_f32_32x32x16_bf16 v[240:255], v[132:135], v[20:23], v[240:255]
    v_exp_f32 v217, v217
    v_exp_f32 v218, v218
    v_exp_f32 v219, v219
    v_smfmac_f32_32x32x32_bf16 v[80:95], v[148:151], v[208:215], v7
    v_exp_f32 v220, v220
    v_exp_f32 v221, v221
    v_exp_f32 v222, v222
    v_exp_f32 v223, v223
    v_exp_f32 v224, v224
    v_exp_f32 v225, v225
    v_smfmac_f32_32x32x32_bf16 v[80:95], v[152:155], v[216:223], v7
    s_waitcnt vmcnt(9)
    v_exp_f32 v226, v226
    v_exp_f32 v227, v227
    v_exp_f32 v228, v228
    v_mfma_f32_32x32x4_2b_bf16 v[192:223], v[164:165], v[24:25], 0 cbsz:1 abid:1
    buffer_load_dwordx4 v[132:135], v4, s[32:35], s67 offen sc1
    v_exp_f32 v229, v229
    v_exp_f32 v230, v230
    v_exp_f32 v231, v231
    v_exp_f32 v232, v232
    v_exp_f32 v233, v233
    v_exp_f32 v234, v234
    v_exp_f32 v235, v235
    v_exp_f32 v236, v236
    v_smfmac_f32_32x32x32_bf16 v[96:111], v[148:151], v[224:231], v7
    v_exp_f32 v237, v237
    v_exp_f32 v238, v238
    v_exp_f32 v239, v239
    v_exp_f32 v240, v240
    v_exp_f32 v241, v241
    v_smfmac_f32_32x32x32_bf16 v[96:111], v[152:155], v[232:239], v7
    v_exp_f32 v242, v242
    v_exp_f32 v243, v243
    v_exp_f32 v244, v244
    v_mfma_f32_32x32x16_bf16 v[192:207], v[136:139], v[8:11], v[192:207]
    v_exp_f32 v245, v245
    v_exp_f32 v246, v246
    v_exp_f32 v247, v247
    v_exp_f32 v248, v248
    v_mfma_f32_32x32x16_bf16 v[208:223], v[136:139], v[12:15], v[208:223]
    v_exp_f32 v249, v249
    v_exp_f32 v250, v250
    v_exp_f32 v251, v251
    v_smfmac_f32_32x32x32_bf16 v[112:127], v[148:151], v[240:247], v7
    v_exp_f32 v252, v252
    v_exp_f32 v253, v253
    v_exp_f32 v254, v254
    v_exp_f32 v255, v255
    v_exp_f32 v192, v192
    v_exp_f32 v193, v193
    v_smfmac_f32_32x32x32_bf16 v[112:127], v[152:155], v[248:255], v7
    buffer_load_dwordx4 v[148:151], v6, s[32:35], s67 offen offset:1024 sc1
    buffer_load_dwordx4 v[152:155], v6, s[32:35], s67 offen offset:1792 sc1
    v_exp_f32 v194, v194
    v_exp_f32 v195, v195
    v_exp_f32 v196, v196
    v_mfma_f32_32x32x4_2b_bf16 v[224:255], v[164:165], v[26:27], 0 cbsz:1 abid:1
    v_exp_f32 v197, v197
    v_exp_f32 v198, v198
    v_exp_f32 v199, v199
    v_exp_f32 v200, v200
    v_exp_f32 v201, v201
    v_exp_f32 v202, v202
    v_exp_f32 v203, v203
    v_exp_f32 v204, v204
    s_waitcnt vmcnt(9)
    v_smfmac_f32_32x32x32_bf16 v[64:79], v[156:159], v[192:199], v7
    v_exp_f32 v205, v205
    v_exp_f32 v206, v206
    v_exp_f32 v207, v207
    v_exp_f32 v208, v208
    v_exp_f32 v209, v209
    v_smfmac_f32_32x32x32_bf16 v[64:79], v[160:163], v[200:207], v7
    s_lshl_b32 s59, s3, 10
    s_add_u32 m0, s59, 0
    s_add_u32 s59, s90, 0
    buffer_load_dwordx4 v168, s[20:23], s59 offen  lds
    s_cmp_eq_u32 s3, 1
    s_cbranch_scc0 L_skip_26
    v_lshlrev_b32 v32, 4, v2
    v_lshl_add_u32 v33, v3, 8, v32
    v_add_u32 v33, 106496, v33
    v_and_b32 v50, 7, v1
    v_lshlrev_b32 v50, 2, v50
    v_add_u32 v50, 163072, v50
    ds_read_b32 v51, v50
    ds_read_b128 v[34:37], v33 offset:0
    ds_read_b128 v[38:41], v33 offset:1024
    ds_read_b128 v[42:45], v33 offset:2048
    ds_read_b128 v[46:49], v33 offset:3072
L_skip_26:
    v_exp_f32 v210, v210
    v_exp_f32 v211, v211
    v_exp_f32 v212, v212
    v_mfma_f32_32x32x16_bf16 v[224:239], v[136:139], v[16:19], v[224:239]
    v_exp_f32 v213, v213
    v_exp_f32 v214, v214
    v_exp_f32 v215, v215
    v_exp_f32 v216, v216
    v_mfma_f32_32x32x16_bf16 v[240:255], v[136:139], v[20:23], v[240:255]
    v_exp_f32 v217, v217
    v_exp_f32 v218, v218
    v_exp_f32 v219, v219
    v_smfmac_f32_32x32x32_bf16 v[80:95], v[156:159], v[208:215], v7
    v_exp_f32 v220, v220
    v_exp_f32 v221, v221
    v_exp_f32 v222, v222
    v_exp_f32 v223, v223
    v_exp_f32 v224, v224
    v_exp_f32 v225, v225
    v_smfmac_f32_32x32x32_bf16 v[80:95], v[160:163], v[216:223], v7
    s_waitcnt vmcnt(7)
    v_exp_f32 v226, v226
    v_exp_f32 v227, v227
    v_exp_f32 v228, v228
    v_mfma_f32_32x32x4_2b_bf16 v[192:223], v[166:167], v[24:25], 0 cbsz:1 abid:0
    buffer_load_dwordx4 v[136:139], v4, s[32:35], s68 offen sc1
    buffer_load_dwordx2 v[164:165], v5, s[32:35], s68 offen offset:2560 sc1
    v_exp_f32 v229, v229
    v_exp_f32 v230, v230
    v_exp_f32 v231, v231
    v_exp_f32 v232, v232
    v_exp_f32 v233, v233
    v_exp_f32 v234, v234
    v_exp_f32 v235, v235
    v_exp_f32 v236, v236
    v_smfmac_f32_32x32x32_bf16 v[96:111], v[156:159], v[224:231], v7
    v_exp_f32 v237, v237
    v_exp_f32 v238, v238
    v_exp_f32 v239, v239
    v_exp_f32 v240, v240
    v_exp_f32 v241, v241
    v_smfmac_f32_32x32x32_bf16 v[96:111], v[160:163], v[232:239], v7
    s_lshl_b32 s59, s3, 10
    s_add_u32 m0, s59, 8192
    s_add_u32 s59, s90, 0
    buffer_load_dwordx4 v169, s[20:23], s59 offen  lds
    s_cmp_eq_u32 s3, 1
    s_cbranch_scc0 L_skip_27
    s_cmp_ge_u32 s2, 96
    s_cbranch_scc0 L_skip_27
    s_waitcnt lgkmcnt(0)
    v_cmp_eq_u32 vcc, 0, v51
    s_cbranch_vccnz L_ltretry
L_ltok:
    v_pk_add_f32 v[34:35], v[34:35], v[38:39]
    v_pk_add_f32 v[36:37], v[36:37], v[40:41]
    v_pk_add_f32 v[42:43], v[42:43], v[46:47]
    v_pk_add_f32 v[44:45], v[44:45], v[48:49]
    v_pk_add_f32 v[34:35], v[34:35], v[42:43]
    v_pk_add_f32 v[36:37], v[36:37], v[44:45]
    v_lshl_add_u32 v32, v3, 2, v32
    v_lshlrev_b32 v54, 3, v3
    v_permlane32_swap_b32 v34, v36
    v_permlane32_swap_b32 v35, v37
    v_add_f32 v34, v34, v36
    v_add_f32 v35, v35, v37
    v_lshrrev_b32 v54, v54, s48
    s_movk_i32 s50, 0xff
    v_permlane16_swap_b32 v34, v35
    v_add_f32 v34, v34, v35
    v_bfi_b32 v187, s50, v54, v34
    buffer_store_dword v187, v32, s[32:35], s84 offen sc1
L_skip_27:
    s_waitcnt lgkmcnt(0)
    v_exp_f32 v242, v242
    v_exp_f32 v243, v243
    v_exp_f32 v244, v244
    v_mfma_f32_32x32x16_bf16 v[192:207], v[128:131], v[8:11], v[192:207]
    v_exp_f32 v245, v245
    v_exp_f32 v246, v246
    v_exp_f32 v247, v247
    v_exp_f32 v248, v248
    v_mfma_f32_32x32x16_bf16 v[208:223], v[128:131], v[12:15], v[208:223]
    v_exp_f32 v249, v249
    v_exp_f32 v250, v250
    v_exp_f32 v251, v251
    v_smfmac_f32_32x32x32_bf16 v[112:127], v[156:159], v[240:247], v7
    v_exp_f32 v252, v252
    v_exp_f32 v253, v253
    v_exp_f32 v254, v254
    v_exp_f32 v255, v255
    v_exp_f32 v192, v192
    v_exp_f32 v193, v193
    v_smfmac_f32_32x32x32_bf16 v[112:127], v[160:163], v[248:255], v7
    buffer_load_dwordx4 v[156:159], v6, s[32:35], s68 offen offset:1024 sc1
    buffer_load_dwordx4 v[160:163], v6, s[32:35], s68 offen offset:1792 sc1
    v_exp_f32 v194, v194
    v_exp_f32 v195, v195
    v_exp_f32 v196, v196
    v_mfma_f32_32x32x4_2b_bf16 v[224:255], v[166:167], v[26:27], 0 cbsz:1 abid:0
    v_exp_f32 v197, v197
    v_exp_f32 v198, v198
    v_exp_f32 v199, v199
    v_exp_f32 v200, v200
    v_exp_f32 v201, v201
    v_exp_f32 v202, v202
    v_exp_f32 v203, v203
    v_exp_f32 v204, v204
    s_waitcnt vmcnt(9)
    v_smfmac_f32_32x32x32_bf16 v[64:79], v[140:143], v[192:199], v7
    v_exp_f32 v205, v205
    v_exp_f32 v206, v206
    v_exp_f32 v207, v207
    v_exp_f32 v208, v208
    v_exp_f32 v209, v209
    v_smfmac_f32_32x32x32_bf16 v[64:79], v[144:147], v[200:207], v7
    v_exp_f32 v210, v210
    v_exp_f32 v211, v211
    v_exp_f32 v212, v212
    v_mfma_f32_32x32x16_bf16 v[224:239], v[128:131], v[16:19], v[224:239]
    v_exp_f32 v213, v213
    v_exp_f32 v214, v214
    v_exp_f32 v215, v215
    v_exp_f32 v216, v216
    v_mfma_f32_32x32x16_bf16 v[240:255], v[128:131], v[20:23], v[240:255]
    s_mov_b32 exec_lo, s93
    s_mov_b32 exec_hi, s93
    buffer_load_dwordx4 v[28:31], v173, s[44:47], s76 offen
    s_mov_b64 exec, -1
    s_add_u32 s76, s76, s77
    s_min_u32 s76, s76, s92
    v_exp_f32 v217, v217
    v_exp_f32 v218, v218
    v_exp_f32 v219, v219
    v_smfmac_f32_32x32x32_bf16 v[80:95], v[140:143], v[208:215], v7
    v_exp_f32 v220, v220
    v_exp_f32 v221, v221
    v_exp_f32 v222, v222
    v_exp_f32 v223, v223
    v_exp_f32 v224, v224
    v_exp_f32 v225, v225
    v_smfmac_f32_32x32x32_bf16 v[80:95], v[144:147], v[216:223], v7
    s_waitcnt vmcnt(9)
    v_exp_f32 v226, v226
    v_exp_f32 v227, v227
    v_exp_f32 v228, v228
    v_mfma_f32_32x32x4_2b_bf16 v[192:223], v[166:167], v[24:25], 0 cbsz:1 abid:1
    buffer_load_dwordx4 v[128:131], v4, s[32:35], s69 offen sc1
    v_exp_f32 v229, v229
    v_exp_f32 v230, v230
    v_exp_f32 v231, v231
    v_exp_f32 v232, v232
    v_exp_f32 v233, v233
    v_exp_f32 v234, v234
    v_exp_f32 v235, v235
    v_exp_f32 v236, v236
    v_smfmac_f32_32x32x32_bf16 v[96:111], v[140:143], v[224:231], v7
    v_exp_f32 v237, v237
    v_exp_f32 v238, v238
    v_exp_f32 v239, v239
    v_exp_f32 v240, v240
    v_exp_f32 v241, v241
    v_smfmac_f32_32x32x32_bf16 v[96:111], v[144:147], v[232:239], v7
    s_lshl_b32 s59, s3, 10
    s_add_u32 m0, s59, 16384
    s_add_u32 s59, s90, 0
    buffer_load_dwordx4 v170, s[20:23], s59 offen  lds
    v_exp_f32 v242, v242
    v_exp_f32 v243, v243
    v_exp_f32 v244, v244
    v_mfma_f32_32x32x16_bf16 v[192:207], v[132:135], v[8:11], v[192:207]
    v_exp_f32 v245, v245
    v_exp_f32 v246, v246
    v_exp_f32 v247, v247
    v_exp_f32 v248, v248
    v_mfma_f32_32x32x16_bf16 v[208:223], v[132:135], v[12:15], v[208:223]
    v_exp_f32 v249, v249
    v_exp_f32 v250, v250
    v_exp_f32 v251, v251
    v_smfmac_f32_32x32x32_bf16 v[112:127], v[140:143], v[240:247], v7
    v_exp_f32 v252, v252
    v_exp_f32 v253, v253
    v_exp_f32 v254, v254
    v_exp_f32 v255, v255
    v_exp_f32 v192, v192
    v_exp_f32 v193, v193
    v_smfmac_f32_32x32x32_bf16 v[112:127], v[144:147], v[248:255], v7
    buffer_load_dwordx4 v[140:143], v6, s[32:35], s69 offen offset:1024 sc1
    buffer_load_dwordx4 v[144:147], v6, s[32:35], s69 offen offset:1792 sc1
    v_exp_f32 v194, v194
    v_exp_f32 v195, v195
    v_exp_f32 v196, v196
    v_mfma_f32_32x32x4_2b_bf16 v[224:255], v[166:167], v[26:27], 0 cbsz:1 abid:1
    v_exp_f32 v197, v197
    v_exp_f32 v198, v198
    v_exp_f32 v199, v199
    v_exp_f32 v200, v200
    v_exp_f32 v201, v201
    v_exp_f32 v202, v202
    v_exp_f32 v203, v203
    v_exp_f32 v204, v204
    s_waitcnt vmcnt(11)
    v_smfmac_f32_32x32x32_bf16 v[64:79], v[148:151], v[192:199], v7
    v_exp_f32 v205, v205
    v_exp_f32 v206, v206
    v_exp_f32 v207, v207
    v_exp_f32 v208, v208
    v_exp_f32 v209, v209
    v_smfmac_f32_32x32x32_bf16 v[64:79], v[152:155], v[200:207], v7
    s_lshl_b32 s59, s3, 10
    s_add_u32 m0, s59, 24576
    s_add_u32 s59, s90, 0
    buffer_load_dwordx4 v171, s[20:23], s59 offen  lds
    v_exp_f32 v210, v210
    v_exp_f32 v211, v211
    v_exp_f32 v212, v212
    v_mfma_f32_32x32x16_bf16 v[224:239], v[132:135], v[16:19], v[224:239]
    v_exp_f32 v213, v213
    v_exp_f32 v214, v214
    v_exp_f32 v215, v215
    v_exp_f32 v216, v216
    v_mfma_f32_32x32x16_bf16 v[240:255], v[132:135], v[20:23], v[240:255]
    v_exp_f32 v217, v217
    v_exp_f32 v218, v218
    v_exp_f32 v219, v219
    v_smfmac_f32_32x32x32_bf16 v[80:95], v[148:151], v[208:215], v7
    v_exp_f32 v220, v220
    v_exp_f32 v221, v221
    v_exp_f32 v222, v222
    v_exp_f32 v223, v223
    v_exp_f32 v224, v224
    v_exp_f32 v225, v225
    v_smfmac_f32_32x32x32_bf16 v[80:95], v[152:155], v[216:223], v7
    s_waitcnt vmcnt(9)
    v_exp_f32 v226, v226
    v_exp_f32 v227, v227
    v_exp_f32 v228, v228
    v_mfma_f32_32x32x4_2b_bf16 v[192:223], v[164:165], v[24:25], 0 cbsz:1 abid:0
    buffer_load_dwordx4 v[132:135], v4, s[32:35], s70 offen sc1
    buffer_load_dwordx2 v[166:167], v5, s[32:35], s70 offen offset:2560 sc1
    v_exp_f32 v229, v229
    v_exp_f32 v230, v230
    v_exp_f32 v231, v231
    v_exp_f32 v232, v232
    v_exp_f32 v233, v233
    v_exp_f32 v234, v234
    v_exp_f32 v235, v235
    v_exp_f32 v236, v236
    v_smfmac_f32_32x32x32_bf16 v[96:111], v[148:151], v[224:231], v7
    v_exp_f32 v237, v237
    v_exp_f32 v238, v238
    v_exp_f32 v239, v239
    v_exp_f32 v240, v240
    v_exp_f32 v241, v241
    v_smfmac_f32_32x32x32_bf16 v[96:111], v[152:155], v[232:239], v7
    s_cmp_eq_u32 s2, 0
    s_cbranch_scc0 L_skip_28
    s_cmp_eq_u32 s3, 0
    s_cbranch_scc0 L_skip_28
    v_mov_b32 v184, s48
    s_mov_b64 exec, 1
    buffer_store_dword v184, v4, s[32:35], 0 offen sc1
    s_mov_b64 exec, -1
L_skip_28:
    v_exp_f32 v242, v242
    v_exp_f32 v243, v243
    v_exp_f32 v244, v244
    v_mfma_f32_32x32x16_bf16 v[192:207], v[136:139], v[8:11], v[192:207]
    v_exp_f32 v245, v245
    v_exp_f32 v246, v246
    v_exp_f32 v247, v247
    v_exp_f32 v248, v248
    v_mfma_f32_32x32x16_bf16 v[208:223], v[136:139], v[12:15], v[208:223]
    s_mov_b32 exec_lo, s93
    s_mov_b32 exec_hi, s93
    buffer_load_dwordx4 v[32:35], v173, s[44:47], s76 offen
    s_mov_b64 exec, -1
    s_add_u32 s76, s76, s77
    s_min_u32 s76, s76, s92
    v_exp_f32 v249, v249
    v_exp_f32 v250, v250
    v_exp_f32 v251, v251
    v_smfmac_f32_32x32x32_bf16 v[112:127], v[148:151], v[240:247], v7
    v_exp_f32 v252, v252
    v_exp_f32 v253, v253
    v_exp_f32 v254, v254
    v_exp_f32 v255, v255
    v_exp_f32 v192, v192
    v_exp_f32 v193, v193
    v_smfmac_f32_32x32x32_bf16 v[112:127], v[152:155], v[248:255], v7
    buffer_load_dwordx4 v[148:151], v6, s[32:35], s70 offen offset:1024 sc1
    buffer_load_dwordx4 v[152:155], v6, s[32:35], s70 offen offset:1792 sc1
    v_exp_f32 v194, v194
    v_exp_f32 v195, v195
    v_exp_f32 v196, v196
    v_mfma_f32_32x32x4_2b_bf16 v[224:255], v[164:165], v[26:27], 0 cbsz:1 abid:0
    v_exp_f32 v197, v197
    v_exp_f32 v198, v198
    v_exp_f32 v199, v199
    v_exp_f32 v200, v200
    v_exp_f32 v201, v201
    v_exp_f32 v202, v202
    v_exp_f32 v203, v203
    v_exp_f32 v204, v204
    s_waitcnt vmcnt(11)
    v_smfmac_f32_32x32x32_bf16 v[64:79], v[156:159], v[192:199], v7
    v_exp_f32 v205, v205
    v_exp_f32 v206, v206
    v_exp_f32 v207, v207
    v_exp_f32 v208, v208
    v_exp_f32 v209, v209
    v_smfmac_f32_32x32x32_bf16 v[64:79], v[160:163], v[200:207], v7
    s_lshl_b32 s59, s3, 10
    s_add_u32 m0, s59, 32768
    s_add_u32 s59, s90, 0
    buffer_load_dwordx4 v172, s[20:23], s59 offen  lds
    v_exp_f32 v210, v210
    v_exp_f32 v211, v211
    v_exp_f32 v212, v212
    v_mfma_f32_32x32x16_bf16 v[224:239], v[136:139], v[16:19], v[224:239]
    v_exp_f32 v213, v213
    v_exp_f32 v214, v214
    v_exp_f32 v215, v215
    v_exp_f32 v216, v216
    v_mfma_f32_32x32x16_bf16 v[240:255], v[136:139], v[20:23], v[240:255]
    v_exp_f32 v217, v217
    v_exp_f32 v218, v218
    v_exp_f32 v219, v219
    v_smfmac_f32_32x32x32_bf16 v[80:95], v[156:159], v[208:215], v7
    v_exp_f32 v220, v220
    v_exp_f32 v221, v221
    v_exp_f32 v222, v222
    v_exp_f32 v223, v223
    v_exp_f32 v224, v224
    v_exp_f32 v225, v225
    v_smfmac_f32_32x32x32_bf16 v[80:95], v[160:163], v[216:223], v7
    s_waitcnt vmcnt(10)
    v_exp_f32 v226, v226
    v_exp_f32 v227, v227
    v_exp_f32 v228, v228
    v_mfma_f32_32x32x4_2b_bf16 v[192:223], v[164:165], v[24:25], 0 cbsz:1 abid:1
    buffer_load_dwordx4 v[136:139], v4, s[32:35], s71 offen sc1
    v_exp_f32 v229, v229
    v_exp_f32 v230, v230
    v_exp_f32 v231, v231
    v_exp_f32 v232, v232
    v_exp_f32 v233, v233
    v_exp_f32 v234, v234
    v_exp_f32 v235, v235
    v_exp_f32 v236, v236
    v_smfmac_f32_32x32x32_bf16 v[96:111], v[156:159], v[224:231], v7
    v_exp_f32 v237, v237
    v_exp_f32 v238, v238
    v_exp_f32 v239, v239
    v_exp_f32 v240, v240
    v_exp_f32 v241, v241
    v_smfmac_f32_32x32x32_bf16 v[96:111], v[160:163], v[232:239], v7
    s_lshl_b32 s59, s3, 10
    s_add_u32 m0, s59, 40960
    s_add_u32 s59, s90, 327680
    buffer_load_dwordx4 v168, s[20:23], s59 offen  lds
    buffer_load_dword v190, v174, s[32:35], s80 offen sc1
    buffer_load_dword v190, v175, s[32:35], s80 offen sc1
    v_exp_f32 v242, v242
    v_exp_f32 v243, v243
    v_exp_f32 v244, v244
    v_mfma_f32_32x32x16_bf16 v[192:207], v[128:131], v[8:11], v[192:207]
    v_exp_f32 v245, v245
    v_exp_f32 v246, v246
    v_exp_f32 v247, v247
    v_exp_f32 v248, v248
    v_mfma_f32_32x32x16_bf16 v[208:223], v[128:131], v[12:15], v[208:223]
    v_exp_f32 v249, v249
    v_exp_f32 v250, v250
    v_exp_f32 v251, v251
    v_smfmac_f32_32x32x32_bf16 v[112:127], v[156:159], v[240:247], v7
    v_exp_f32 v252, v252
    v_exp_f32 v253, v253
    v_exp_f32 v254, v254
    v_exp_f32 v255, v255
    v_exp_f32 v192, v192
    v_exp_f32 v193, v193
    v_smfmac_f32_32x32x32_bf16 v[112:127], v[160:163], v[248:255], v7
    buffer_load_dwordx4 v[156:159], v6, s[32:35], s71 offen offset:1024 sc1
    buffer_load_dwordx4 v[160:163], v6, s[32:35], s71 offen offset:1792 sc1
    v_exp_f32 v194, v194
    v_exp_f32 v195, v195
    v_exp_f32 v196, v196
    v_mfma_f32_32x32x4_2b_bf16 v[224:255], v[164:165], v[26:27], 0 cbsz:1 abid:1
    v_exp_f32 v197, v197
    v_exp_f32 v198, v198
    v_exp_f32 v199, v199
    v_exp_f32 v200, v200
    v_exp_f32 v201, v201
    v_exp_f32 v202, v202
    v_exp_f32 v203, v203
    v_exp_f32 v204, v204
    s_waitcnt vmcnt(13)
    v_smfmac_f32_32x32x32_bf16 v[64:79], v[140:143], v[192:199], v7
    v_exp_f32 v205, v205
    v_exp_f32 v206, v206
    v_exp_f32 v207, v207
    v_exp_f32 v208, v208
    v_exp_f32 v209, v209
    v_smfmac_f32_32x32x32_bf16 v[64:79], v[144:147], v[200:207], v7
    s_lshl_b32 s50, s4, 13
    s_lshl_b32 s51, s5, 10
    s_add_u32 s50, s50, s51
    s_add_u32 s50, s50, 196608
    buffer_load_dword v190, v4, s[32:35], s50 offen sc1
    v_exp_f32 v210, v210
    v_exp_f32 v211, v211
    v_exp_f32 v212, v212
    v_mfma_f32_32x32x16_bf16 v[224:239], v[128:131], v[16:19], v[224:239]
    v_exp_f32 v213, v213
    v_exp_f32 v214, v214
    v_exp_f32 v215, v215
    v_exp_f32 v216, v216
    v_mfma_f32_32x32x16_bf16 v[240:255], v[128:131], v[20:23], v[240:255]
    s_mov_b32 exec_lo, s93
    s_mov_b32 exec_hi, s93
    buffer_load_dwordx4 v[36:39], v173, s[44:47], s76 offen
    s_mov_b64 exec, -1
    s_add_u32 s76, s76, s77
    s_min_u32 s76, s76, s92
    v_exp_f32 v217, v217
    v_exp_f32 v218, v218
    v_exp_f32 v219, v219
    v_smfmac_f32_32x32x32_bf16 v[80:95], v[140:143], v[208:215], v7
    v_exp_f32 v220, v220
    v_exp_f32 v221, v221
    v_exp_f32 v222, v222
    v_exp_f32 v223, v223
    v_exp_f32 v224, v224
    v_exp_f32 v225, v225
    v_smfmac_f32_32x32x32_bf16 v[80:95], v[144:147], v[216:223], v7
    s_waitcnt vmcnt(12)
    v_exp_f32 v226, v226
    v_exp_f32 v227, v227
    v_exp_f32 v228, v228
    v_mfma_f32_32x32x4_2b_bf16 v[192:223], v[166:167], v[24:25], 0 cbsz:1 abid:0
    buffer_load_dwordx4 v[128:131], v4, s[32:35], s72 offen sc1
    buffer_load_dwordx2 v[164:165], v5, s[32:35], s72 offen offset:2560 sc1
    v_exp_f32 v229, v229
    v_exp_f32 v230, v230
    v_exp_f32 v231, v231
    v_exp_f32 v232, v232
    v_exp_f32 v233, v233
    v_exp_f32 v234, v234
    v_exp_f32 v235, v235
    v_exp_f32 v236, v236
    v_smfmac_f32_32x32x32_bf16 v[96:111], v[140:143], v[224:231], v7
    v_exp_f32 v237, v237
    v_exp_f32 v238, v238
    v_exp_f32 v239, v239
    v_exp_f32 v240, v240
    v_exp_f32 v241, v241
    v_smfmac_f32_32x32x32_bf16 v[96:111], v[144:147], v[232:239], v7
    s_lshl_b32 s59, s3, 10
    s_add_u32 m0, s59, 49152
    s_add_u32 s59, s90, 327680
    buffer_load_dwordx4 v169, s[20:23], s59 offen  lds
    v_exp_f32 v242, v242
    v_exp_f32 v243, v243
    v_exp_f32 v244, v244
    v_mfma_f32_32x32x16_bf16 v[192:207], v[132:135], v[8:11], v[192:207]
    v_exp_f32 v245, v245
    v_exp_f32 v246, v246
    v_exp_f32 v247, v247
    v_exp_f32 v248, v248
    v_mfma_f32_32x32x16_bf16 v[208:223], v[132:135], v[12:15], v[208:223]
    v_exp_f32 v249, v249
    v_exp_f32 v250, v250
    v_exp_f32 v251, v251
    v_smfmac_f32_32x32x32_bf16 v[112:127], v[140:143], v[240:247], v7
    v_exp_f32 v252, v252
    v_exp_f32 v253, v253
    v_exp_f32 v254, v254
    v_exp_f32 v255, v255
    v_exp_f32 v192, v192
    v_exp_f32 v193, v193
    v_smfmac_f32_32x32x32_bf16 v[112:127], v[144:147], v[248:255], v7
    buffer_load_dwordx4 v[140:143], v6, s[32:35], s72 offen offset:1024 sc1
    buffer_load_dwordx4 v[144:147], v6, s[32:35], s72 offen offset:1792 sc1
    v_exp_f32 v194, v194
    v_exp_f32 v195, v195
    v_exp_f32 v196, v196
    v_mfma_f32_32x32x4_2b_bf16 v[224:255], v[166:167], v[26:27], 0 cbsz:1 abid:0
    v_exp_f32 v197, v197
    v_exp_f32 v198, v198
    v_exp_f32 v199, v199
    v_exp_f32 v200, v200
    v_exp_f32 v201, v201
    v_exp_f32 v202, v202
    v_exp_f32 v203, v203
    v_exp_f32 v204, v204
    s_waitcnt vmcnt(14)
    v_smfmac_f32_32x32x32_bf16 v[64:79], v[148:151], v[192:199], v7
    v_exp_f32 v205, v205
    v_exp_f32 v206, v206
    v_exp_f32 v207, v207
    v_exp_f32 v208, v208
    v_exp_f32 v209, v209
    v_smfmac_f32_32x32x32_bf16 v[64:79], v[152:155], v[200:207], v7
    s_lshl_b32 s59, s3, 10
    s_add_u32 m0, s59, 57344
    s_add_u32 s59, s90, 327680
    buffer_load_dwordx4 v170, s[20:23], s59 offen  lds
    v_exp_f32 v210, v210
    v_exp_f32 v211, v211
    v_exp_f32 v212, v212
    v_mfma_f32_32x32x16_bf16 v[224:239], v[132:135], v[16:19], v[224:239]
    v_exp_f32 v213, v213
    v_exp_f32 v214, v214
    v_exp_f32 v215, v215
    v_exp_f32 v216, v216
    v_mfma_f32_32x32x16_bf16 v[240:255], v[132:135], v[20:23], v[240:255]
    v_exp_f32 v217, v217
    v_exp_f32 v218, v218
    v_exp_f32 v219, v219
    v_smfmac_f32_32x32x32_bf16 v[80:95], v[148:151], v[208:215], v7
    v_exp_f32 v220, v220
    v_exp_f32 v221, v221
    v_exp_f32 v222, v222
    v_exp_f32 v223, v223
    v_exp_f32 v224, v224
    v_exp_f32 v225, v225
    v_smfmac_f32_32x32x32_bf16 v[80:95], v[152:155], v[216:223], v7
    s_waitcnt vmcnt(13)
    v_exp_f32 v226, v226
    v_exp_f32 v227, v227
    v_exp_f32 v228, v228
    v_mfma_f32_32x32x4_2b_bf16 v[192:223], v[166:167], v[24:25], 0 cbsz:1 abid:1
    buffer_load_dwordx4 v[132:135], v4, s[32:35], s73 offen sc1
    v_exp_f32 v229, v229
    v_exp_f32 v230, v230
    v_exp_f32 v231, v231
    v_exp_f32 v232, v232
    v_exp_f32 v233, v233
    v_exp_f32 v234, v234
    v_exp_f32 v235, v235
    v_exp_f32 v236, v236
    v_smfmac_f32_32x32x32_bf16 v[96:111], v[148:151], v[224:231], v7
    v_exp_f32 v237, v237
    v_exp_f32 v238, v238
    v_exp_f32 v239, v239
    v_exp_f32 v240, v240
    v_exp_f32 v241, v241
    v_smfmac_f32_32x32x32_bf16 v[96:111], v[152:155], v[232:239], v7
    s_cmp_ge_u32 s3, 4
    s_cbranch_scc0 L_bgh_29
    buffer_load_dwordx4 v[176:179], v62, s[8:11], s82 offen offset:0
    s_branch L_bgj_30
L_bgh_29:
    s_mul_i32 s50, s6, 2560
    s_lshl_b32 s51, s90, 1
    s_add_u32 s50, s50, s51
    s_add_u32 s54, s50, 9216
    s_add_u32 s55, s54, 30720
    v_lshrrev_b32 v186, 5, v1
    v_mul_u32_u24 v186, 14848, v186
    v_add_u32 v186, v186, v4
    s_mov_b64 exec, 0xfffff
    buffer_load_dwordx2 v[184:185], v5, s[40:43], s90 offen
    s_mov_b64 exec, -1
L_bgj_30:
    v_exp_f32 v242, v242
    v_exp_f32 v243, v243
    v_exp_f32 v244, v244
    v_mfma_f32_32x32x16_bf16 v[192:207], v[136:139], v[8:11], v[192:207]
    v_exp_f32 v245, v245
    v_exp_f32 v246, v246
    v_exp_f32 v247, v247
    v_exp_f32 v248, v248
    v_mfma_f32_32x32x16_bf16 v[208:223], v[136:139], v[12:15], v[208:223]
    s_mov_b32 exec_lo, s93
    s_mov_b32 exec_hi, s93
    buffer_load_dwordx4 v[40:43], v173, s[44:47], s76 offen
    s_mov_b64 exec, -1
    s_add_u32 s76, s76, s77
    s_min_u32 s76, s76, s92
    v_exp_f32 v249, v249
    v_exp_f32 v250, v250
    v_exp_f32 v251, v251
    v_smfmac_f32_32x32x32_bf16 v[112:127], v[148:151], v[240:247], v7
    v_exp_f32 v252, v252
    v_exp_f32 v253, v253
    v_exp_f32 v254, v254
    v_exp_f32 v255, v255
    v_exp_f32 v192, v192
    v_exp_f32 v193, v193
    v_smfmac_f32_32x32x32_bf16 v[112:127], v[152:155], v[248:255], v7
    buffer_load_dwordx4 v[148:151], v6, s[32:35], s73 offen offset:1024 sc1
    buffer_load_dwordx4 v[152:155], v6, s[32:35], s73 offen offset:1792 sc1
    v_exp_f32 v194, v194
    v_exp_f32 v195, v195
    v_exp_f32 v196, v196
    v_mfma_f32_32x32x4_2b_bf16 v[224:255], v[166:167], v[26:27], 0 cbsz:1 abid:1
    v_exp_f32 v197, v197
    v_exp_f32 v198, v198
    v_exp_f32 v199, v199
    v_exp_f32 v200, v200
    v_exp_f32 v201, v201
    v_exp_f32 v202, v202
    v_exp_f32 v203, v203
    v_exp_f32 v204, v204
    s_waitcnt vmcnt(13)
    v_smfmac_f32_32x32x32_bf16 v[64:79], v[156:159], v[192:199], v7
    v_exp_f32 v205, v205
    v_exp_f32 v206, v206
    v_exp_f32 v207, v207
    v_exp_f32 v208, v208
    v_exp_f32 v209, v209
    v_smfmac_f32_32x32x32_bf16 v[64:79], v[160:163], v[200:207], v7
    s_lshl_b32 s59, s3, 10
    s_add_u32 m0, s59, 65536
    s_add_u32 s59, s90, 327680
    buffer_load_dwordx4 v171, s[20:23], s59 offen  lds
    v_exp_f32 v210, v210
    v_exp_f32 v211, v211
    v_exp_f32 v212, v212
    v_mfma_f32_32x32x16_bf16 v[224:239], v[136:139], v[16:19], v[224:239]
    v_exp_f32 v213, v213
    v_exp_f32 v214, v214
    v_exp_f32 v215, v215
    v_exp_f32 v216, v216
    v_mfma_f32_32x32x16_bf16 v[240:255], v[136:139], v[20:23], v[240:255]
    v_exp_f32 v217, v217
    v_exp_f32 v218, v218
    v_exp_f32 v219, v219
    v_smfmac_f32_32x32x32_bf16 v[80:95], v[156:159], v[208:215], v7
    v_exp_f32 v220, v220
    v_exp_f32 v221, v221
    v_exp_f32 v222, v222
    v_exp_f32 v223, v223
    v_exp_f32 v224, v224
    v_exp_f32 v225, v225
    v_smfmac_f32_32x32x32_bf16 v[80:95], v[160:163], v[216:223], v7
    s_waitcnt vmcnt(10)
    v_exp_f32 v226, v226
    v_exp_f32 v227, v227
    v_exp_f32 v228, v228
    v_mfma_f32_32x32x4_2b_bf16 v[192:223], v[164:165], v[24:25], 0 cbsz:1 abid:0
    buffer_load_dwordx4 v[136:139], v4, s[32:35], s74 offen sc1
    buffer_load_dwordx2 v[166:167], v5, s[32:35], s74 offen offset:2560 sc1
    v_exp_f32 v229, v229
    v_exp_f32 v230, v230
    v_exp_f32 v231, v231
    v_exp_f32 v232, v232
    v_exp_f32 v233, v233
    v_exp_f32 v234, v234
    v_exp_f32 v235, v235
    v_exp_f32 v236, v236
    v_smfmac_f32_32x32x32_bf16 v[96:111], v[156:159], v[224:231], v7
    v_exp_f32 v237, v237
    v_exp_f32 v238, v238
    v_exp_f32 v239, v239
    v_exp_f32 v240, v240
    v_exp_f32 v241, v241
    v_smfmac_f32_32x32x32_bf16 v[96:111], v[160:163], v[232:239], v7
    s_lshl_b32 s59, s3, 10
    s_add_u32 m0, s59, 73728
    s_add_u32 s59, s90, 327680
    buffer_load_dwordx4 v172, s[20:23], s59 offen  lds
    s_waitcnt vmcnt(12)
    s_mov_b64 exec, 1
    ds_write_b32 v63, v7 offset:32
    s_mov_b64 exec, -1
    v_exp_f32 v242, v242
    v_exp_f32 v243, v243
    v_exp_f32 v244, v244
    v_mfma_f32_32x32x16_bf16 v[192:207], v[128:131], v[8:11], v[192:207]
    v_exp_f32 v245, v245
    v_exp_f32 v246, v246
    v_exp_f32 v247, v247
    v_exp_f32 v248, v248
    v_mfma_f32_32x32x16_bf16 v[208:223], v[128:131], v[12:15], v[208:223]
    v_exp_f32 v249, v249
    v_exp_f32 v250, v250
    v_exp_f32 v251, v251
    v_smfmac_f32_32x32x32_bf16 v[112:127], v[156:159], v[240:247], v7
    v_exp_f32 v252, v252
    v_exp_f32 v253, v253
    v_exp_f32 v254, v254
    v_exp_f32 v255, v255
    v_exp_f32 v192, v192
    v_exp_f32 v193, v193
    v_smfmac_f32_32x32x32_bf16 v[112:127], v[160:163], v[248:255], v7
    buffer_load_dwordx4 v[156:159], v6, s[32:35], s74 offen offset:1024 sc1
    buffer_load_dwordx4 v[160:163], v6, s[32:35], s74 offen offset:1792 sc1
    v_exp_f32 v194, v194
    v_exp_f32 v195, v195
    v_exp_f32 v196, v196
    v_mfma_f32_32x32x4_2b_bf16 v[224:255], v[164:165], v[26:27], 0 cbsz:1 abid:0
    v_exp_f32 v197, v197
    v_exp_f32 v198, v198
    v_exp_f32 v199, v199
    v_exp_f32 v200, v200
    v_exp_f32 v201, v201
    v_exp_f32 v202, v202
    v_exp_f32 v203, v203
    v_exp_f32 v204, v204
    s_waitcnt vmcnt(12)
    v_smfmac_f32_32x32x32_bf16 v[64:79], v[140:143], v[192:199], v7
    v_exp_f32 v205, v205
    v_exp_f32 v206, v206
    v_exp_f32 v207, v207
    v_exp_f32 v208, v208
    v_exp_f32 v209, v209
    v_smfmac_f32_32x32x32_bf16 v[64:79], v[144:147], v[200:207], v7
    s_cmp_ge_u32 s3, 4
    s_cbranch_scc0 L_bgh_31
    buffer_load_dwordx4 v[180:183], v62, s[8:11], s82 offen offset:16
    s_branch L_bgj_32
L_bgh_31:
    s_mov_b32 exec_lo, 0xfffff
    s_mov_b32 exec_hi, 0xfffff
    buffer_load_dwordx4 v[176:179], v186, s[32:35], s54 offen sc1
    s_mov_b64 exec, -1
L_bgj_32:
    v_exp_f32 v210, v210
    v_exp_f32 v211, v211
    v_exp_f32 v212, v212
    v_mfma_f32_32x32x16_bf16 v[224:239], v[128:131], v[16:19], v[224:239]
    v_exp_f32 v213, v213
    v_exp_f32 v214, v214
    v_exp_f32 v215, v215
    v_exp_f32 v216, v216
    v_mfma_f32_32x32x16_bf16 v[240:255], v[128:131], v[20:23], v[240:255]
    s_mov_b32 exec_lo, s93
    s_mov_b32 exec_hi, s93
    buffer_load_dwordx4 v[44:47], v173, s[44:47], s76 offen
    s_mov_b64 exec, -1
    s_add_u32 s76, s76, s77
    s_min_u32 s76, s76, s92
    v_exp_f32 v217, v217
    v_exp_f32 v218, v218
    v_exp_f32 v219, v219
    v_smfmac_f32_32x32x32_bf16 v[80:95], v[140:143], v[208:215], v7
    v_exp_f32 v220, v220
    v_exp_f32 v221, v221
    v_exp_f32 v222, v222
    v_exp_f32 v223, v223
    v_exp_f32 v224, v224
    v_exp_f32 v225, v225
    v_smfmac_f32_32x32x32_bf16 v[80:95], v[144:147], v[216:223], v7
    s_waitcnt vmcnt(12)
    v_exp_f32 v226, v226
    v_exp_f32 v227, v227
    v_exp_f32 v228, v228
    v_mfma_f32_32x32x4_2b_bf16 v[192:223], v[164:165], v[24:25], 0 cbsz:1 abid:1
    buffer_load_dwordx4 v[128:131], v4, s[32:35], s75 offen sc1
    v_exp_f32 v229, v229
    v_exp_f32 v230, v230
    v_exp_f32 v231, v231
    v_exp_f32 v232, v232
    v_exp_f32 v233, v233
    v_exp_f32 v234, v234
    v_exp_f32 v235, v235
    v_exp_f32 v236, v236
    v_smfmac_f32_32x32x32_bf16 v[96:111], v[140:143], v[224:231], v7
    v_exp_f32 v237, v237
    v_exp_f32 v238, v238
    v_exp_f32 v239, v239
    v_exp_f32 v240, v240
    v_exp_f32 v241, v241
    v_smfmac_f32_32x32x32_bf16 v[96:111], v[144:147], v[232:239], v7
    s_lshl_b32 s59, s3, 10
    s_add_u32 m0, s59, 81920
    s_add_u32 s59, s90, 655360
    buffer_load_dwordx4 v168, s[20:23], s59 offen  lds
    s_cmp_ge_u32 s3, 4
    s_cbranch_scc0 L_bgh_33
    buffer_load_dwordx2 v[184:185], v62, s[8:11], s82 offen offset:32
    s_branch L_bgj_34
L_bgh_33:
    s_mov_b32 exec_lo, 0xfffff
    s_mov_b32 exec_hi, 0xfffff
    buffer_load_dwordx4 v[180:183], v186, s[32:35], s55 offen sc1
    s_mov_b64 exec, -1
L_bgj_34:
    v_lshlrev_b32 v189, 2, v1
    buffer_load_dword v188, v189, s[32:35], s58 offen sc1
    v_exp_f32 v242, v242
    v_exp_f32 v243, v243
    v_exp_f32 v244, v244
    v_mfma_f32_32x32x16_bf16 v[192:207], v[132:135], v[8:11], v[192:207]
    v_exp_f32 v245, v245
    v_exp_f32 v246, v246
    v_exp_f32 v247, v247
    v_exp_f32 v248, v248
    v_mfma_f32_32x32x16_bf16 v[208:223], v[132:135], v[12:15], v[208:223]
    v_exp_f32 v249, v249
    v_exp_f32 v250, v250
    v_exp_f32 v251, v251
    v_smfmac_f32_32x32x32_bf16 v[112:127], v[140:143], v[240:247], v7
    v_exp_f32 v252, v252
    v_exp_f32 v253, v253
    v_exp_f32 v254, v254
    v_exp_f32 v255, v255
    s_setprio 1
    v_exp_f32 v192, v192
    v_exp_f32 v193, v193
    v_smfmac_f32_32x32x32_bf16 v[112:127], v[144:147], v[248:255], v7
    buffer_load_dwordx4 v[140:143], v6, s[32:35], s75 offen offset:1024 sc1
    buffer_load_dwordx4 v[144:147], v6, s[32:35], s75 offen offset:1792 sc1
    v_exp_f32 v194, v194
    v_exp_f32 v195, v195
    v_exp_f32 v196, v196
    v_mfma_f32_32x32x4_2b_bf16 v[224:255], v[164:165], v[26:27], 0 cbsz:1 abid:1
    v_exp_f32 v197, v197
    v_exp_f32 v198, v198
    v_exp_f32 v199, v199
    v_exp_f32 v200, v200
    v_exp_f32 v201, v201
    v_exp_f32 v202, v202
    v_exp_f32 v203, v203
    v_exp_f32 v204, v204
    s_waitcnt vmcnt(14)
    v_smfmac_f32_32x32x32_bf16 v[64:79], v[148:151], v[192:199], v7
    v_exp_f32 v205, v205
    v_exp_f32 v206, v206
    v_exp_f32 v207, v207
    v_exp_f32 v208, v208
    v_exp_f32 v209, v209
    v_smfmac_f32_32x32x32_bf16 v[64:79], v[152:155], v[200:207], v7
    s_lshl_b32 s59, s3, 10
    s_add_u32 m0, s59, 90112
    s_add_u32 s59, s90, 655360
    buffer_load_dwordx4 v169, s[20:23], s59 offen  lds
    v_exp_f32 v210, v210
    v_exp_f32 v211, v211
    v_exp_f32 v212, v212
    v_mfma_f32_32x32x16_bf16 v[224:239], v[132:135], v[16:19], v[224:239]
    v_exp_f32 v213, v213
    v_exp_f32 v214, v214
    v_exp_f32 v215, v215
    v_exp_f32 v216, v216
    v_mfma_f32_32x32x16_bf16 v[240:255], v[132:135], v[20:23], v[240:255]
    v_exp_f32 v217, v217
    v_exp_f32 v218, v218
    v_exp_f32 v219, v219
    v_smfmac_f32_32x32x32_bf16 v[80:95], v[148:151], v[208:215], v7
    v_exp_f32 v220, v220
    v_exp_f32 v221, v221
    v_exp_f32 v222, v222
    v_exp_f32 v223, v223
    v_exp_f32 v224, v224
    v_exp_f32 v225, v225
    v_smfmac_f32_32x32x32_bf16 v[80:95], v[152:155], v[216:223], v7
    s_waitcnt vmcnt(12)
    v_exp_f32 v226, v226
    v_exp_f32 v227, v227
    v_exp_f32 v228, v228
    v_mfma_f32_32x32x4_2b_bf16 v[192:223], v[166:167], v[24:25], 0 cbsz:1 abid:0
    v_exp_f32 v229, v229
    v_exp_f32 v230, v230
    v_exp_f32 v231, v231
    v_exp_f32 v232, v232
    v_exp_f32 v233, v233
    v_exp_f32 v234, v234
    v_exp_f32 v235, v235
    v_exp_f32 v236, v236
    v_smfmac_f32_32x32x32_bf16 v[96:111], v[148:151], v[224:231], v7
    v_exp_f32 v237, v237
    v_exp_f32 v238, v238
    v_exp_f32 v239, v239
    v_exp_f32 v240, v240
    v_exp_f32 v241, v241
    v_smfmac_f32_32x32x32_bf16 v[96:111], v[152:155], v[232:239], v7
    v_exp_f32 v242, v242
    v_exp_f32 v243, v243
    v_exp_f32 v244, v244
    v_mfma_f32_32x32x16_bf16 v[192:207], v[136:139], v[8:11], v[192:207]
    v_exp_f32 v245, v245
    v_exp_f32 v246, v246
    v_exp_f32 v247, v247
    v_exp_f32 v248, v248
    v_mfma_f32_32x32x16_bf16 v[208:223], v[136:139], v[12:15], v[208:223]
    s_cmp_ge_u32 s2, 216
    s_cselect_b32 s93, s93, 1
    s_mov_b32 exec_lo, s93
    s_mov_b32 exec_hi, s93
    buffer_load_dwordx4 v[48:51], v173, s[44:47], s76 offen
    s_mov_b64 exec, -1
    s_add_u32 s76, s76, s77
    s_min_u32 s76, s76, s92
    v_exp_f32 v249, v249
    v_exp_f32 v250, v250
    v_exp_f32 v251, v251
    v_smfmac_f32_32x32x32_bf16 v[112:127], v[148:151], v[240:247], v7
    v_exp_f32 v252, v252
    v_exp_f32 v253, v253
    v_exp_f32 v254, v254
    v_exp_f32 v255, v255
    v_exp_f32 v192, v192
    v_exp_f32 v193, v193
    v_smfmac_f32_32x32x32_bf16 v[112:127], v[152:155], v[248:255], v7
    v_exp_f32 v194, v194
    v_exp_f32 v195, v195
    v_exp_f32 v196, v196
    v_mfma_f32_32x32x4_2b_bf16 v[224:255], v[166:167], v[26:27], 0 cbsz:1 abid:0
    v_exp_f32 v197, v197
    v_exp_f32 v198, v198
    v_exp_f32 v199, v199
    v_exp_f32 v200, v200
    v_exp_f32 v201, v201
    v_exp_f32 v202, v202
    v_exp_f32 v203, v203
    v_exp_f32 v204, v204
    s_waitcnt vmcnt(10)
    v_smfmac_f32_32x32x32_bf16 v[64:79], v[156:159], v[192:199], v7
    v_exp_f32 v205, v205
    v_exp_f32 v206, v206
    v_exp_f32 v207, v207
    v_exp_f32 v208, v208
    v_exp_f32 v209, v209
    v_smfmac_f32_32x32x32_bf16 v[64:79], v[160:163], v[200:207], v7
    s_lshl_b32 s59, s3, 10
    s_add_u32 m0, s59, 98304
    s_add_u32 s59, s90, 655360
    buffer_load_dwordx4 v170, s[20:23], s59 offen  lds
    v_exp_f32 v210, v210
    v_exp_f32 v211, v211
    v_exp_f32 v212, v212
    v_mfma_f32_32x32x16_bf16 v[224:239], v[136:139], v[16:19], v[224:239]
    v_exp_f32 v213, v213
    v_exp_f32 v214, v214
    v_exp_f32 v215, v215
    v_exp_f32 v216, v216
    v_mfma_f32_32x32x16_bf16 v[240:255], v[136:139], v[20:23], v[240:255]
    s_mov_b32 exec_lo, s93
    s_mov_b32 exec_hi, s93
    buffer_load_dwordx4 v[52:55], v173, s[44:47], s76 offen
    s_mov_b64 exec, -1
    s_add_u32 s76, s76, s77
    s_min_u32 s76, s76, s92
    v_exp_f32 v217, v217
    v_exp_f32 v218, v218
    v_exp_f32 v219, v219
    v_smfmac_f32_32x32x32_bf16 v[80:95], v[156:159], v[208:215], v7
    v_exp_f32 v220, v220
    v_exp_f32 v221, v221
    v_exp_f32 v222, v222
    v_exp_f32 v223, v223
    v_exp_f32 v224, v224
    v_exp_f32 v225, v225
    v_smfmac_f32_32x32x32_bf16 v[80:95], v[160:163], v[216:223], v7
    s_waitcnt vmcnt(9)
    v_exp_f32 v226, v226
    v_exp_f32 v227, v227
    v_exp_f32 v228, v228
    v_mfma_f32_32x32x4_2b_bf16 v[192:223], v[166:167], v[24:25], 0 cbsz:1 abid:1
    v_exp_f32 v229, v229
    v_exp_f32 v230, v230
    v_exp_f32 v231, v231
    v_exp_f32 v232, v232
    v_exp_f32 v233, v233
    v_exp_f32 v234, v234
    v_exp_f32 v235, v235
    v_exp_f32 v236, v236
    v_smfmac_f32_32x32x32_bf16 v[96:111], v[156:159], v[224:231], v7
    v_exp_f32 v237, v237
    v_exp_f32 v238, v238
    v_exp_f32 v239, v239
    v_exp_f32 v240, v240
    v_exp_f32 v241, v241
    v_smfmac_f32_32x32x32_bf16 v[96:111], v[160:163], v[232:239], v7
    s_waitcnt vmcnt(6)
    v_cmp_ne_u32 s[52:53], s91, v188
    v_xor_b32 v191, s48, v188
    v_cmp_lt_u32 vcc, 15, v191
    s_cbranch_vccnz L_pfretry
L_pfok:
    s_cmp_eq_u64 s[52:53], 0
    s_cselect_b32 s85, 1, 0
    s_and_b32 s50, s3, 4
    s_add_u32 s51, s3, 0
    s_and_b32 s51, s51, 3
    s_or_b32 s51, s51, s50
    s_mul_i32 s51, s51, 6144
    s_add_u32 s51, s51, 110592
    v_add_u32 v168, s51, v4
    s_add_u32 s51, s3, 1
    s_and_b32 s51, s51, 3
    s_or_b32 s51, s51, s50
    s_mul_i32 s51, s51, 6144
    s_add_u32 s51, s51, 110592
    v_add_u32 v169, s51, v4
    s_add_u32 s51, s3, 2
    s_and_b32 s51, s51, 3
    s_or_b32 s51, s51, s50
    s_mul_i32 s51, s51, 6144
    s_add_u32 s51, s51, 112640
    v_add_u32 v170, s51, v4
    s_add_u32 s51, s3, 3
    s_and_b32 s51, s51, 3
    s_or_b32 s51, s51, s50
    s_mul_i32 s51, s51, 6144
    s_add_u32 s51, s51, 114688
    v_add_u32 v171, s51, v4
    s_xor_b32 s52, s81, 256
    s_add_u32 s60, s52, 0
    s_add_u32 s61, s52, 4096
    s_add_u32 s62, s52, 8192
    s_add_u32 s63, s52, 12288
    s_add_u32 s64, s52, 16384
    s_add_u32 s65, s81, 0
    s_add_u32 s66, s81, 4096
    s_add_u32 s67, s81, 8192
    s_add_u32 s68, s81, 12288
    s_add_u32 s69, s81, 16384
    s_movk_i32 s50, 0x3f80
    s_mov_b32 s51, 0x3f800000
    v_exp_f32 v242, v242
    v_exp_f32 v243, v243
    v_exp_f32 v244, v244
    v_mfma_f32_32x32x16_bf16 v[192:207], v[128:131], v[8:11], v[192:207]
    v_exp_f32 v245, v245
    v_exp_f32 v246, v246
    v_exp_f32 v247, v247
    v_exp_f32 v248, v248
    v_mfma_f32_32x32x16_bf16 v[208:223], v[128:131], v[12:15], v[208:223]
    v_exp_f32 v249, v249
    v_exp_f32 v250, v250
    v_exp_f32 v251, v251
    v_smfmac_f32_32x32x32_bf16 v[112:127], v[156:159], v[240:247], v7
    v_exp_f32 v252, v252
    v_exp_f32 v253, v253
    v_exp_f32 v254, v254
    v_exp_f32 v255, v255
    s_setprio 0
    v_exp_f32 v192, v192
    v_exp_f32 v193, v193
    v_smfmac_f32_32x32x32_bf16 v[112:127], v[160:163], v[248:255], v7
    v_exp_f32 v194, v194
    v_exp_f32 v195, v195
    v_exp_f32 v196, v196
    v_mfma_f32_32x32x4_2b_bf16 v[224:255], v[166:167], v[26:27], 0 cbsz:1 abid:1
    v_exp_f32 v197, v197
    v_exp_f32 v198, v198
    v_exp_f32 v199, v199
    v_exp_f32 v200, v200
    v_exp_f32 v201, v201
    v_exp_f32 v202, v202
    v_exp_f32 v203, v203
    v_exp_f32 v204, v204
    s_waitcnt vmcnt(4)
    v_smfmac_f32_32x32x32_bf16 v[64:79], v[140:143], v[192:199], v7
    v_exp_f32 v205, v205
    v_exp_f32 v206, v206
    v_exp_f32 v207, v207
    v_exp_f32 v208, v208
    v_exp_f32 v209, v209
    v_smfmac_f32_32x32x32_bf16 v[64:79], v[144:147], v[200:207], v7
    v_exp_f32 v210, v210
    v_exp_f32 v211, v211
    v_exp_f32 v212, v212
    v_mfma_f32_32x32x16_bf16 v[224:239], v[128:131], v[16:19], v[224:239]
    v_exp_f32 v213, v213
    v_exp_f32 v214, v214
    v_exp_f32 v215, v215
    v_exp_f32 v216, v216
    v_mfma_f32_32x32x16_bf16 v[240:255], v[128:131], v[20:23], v[240:255]
    v_exp_f32 v217, v217
    v_exp_f32 v218, v218
    v_exp_f32 v219, v219
    v_smfmac_f32_32x32x32_bf16 v[80:95], v[140:143], v[208:215], v7
    v_exp_f32 v220, v220
    v_exp_f32 v221, v221
    v_exp_f32 v222, v222
    v_exp_f32 v223, v223
    v_exp_f32 v224, v224
    v_exp_f32 v225, v225
    v_smfmac_f32_32x32x32_bf16 v[80:95], v[144:147], v[216:223], v7
    v_exp_f32 v226, v226
    v_exp_f32 v227, v227
    v_exp_f32 v228, v228
    v_exp_f32 v229, v229
    v_exp_f32 v230, v230
    v_exp_f32 v231, v231
    v_exp_f32 v232, v232
    v_exp_f32 v233, v233
    v_exp_f32 v234, v234
    v_exp_f32 v235, v235
    v_exp_f32 v236, v236
    v_smfmac_f32_32x32x32_bf16 v[96:111], v[140:143], v[224:231], v7
    v_exp_f32 v237, v237
    v_exp_f32 v238, v238
    v_exp_f32 v239, v239
    v_exp_f32 v240, v240
    v_exp_f32 v241, v241
    v_smfmac_f32_32x32x32_bf16 v[96:111], v[144:147], v[232:239], v7
    v_exp_f32 v242, v242
    v_exp_f32 v243, v243
    v_exp_f32 v244, v244
    v_exp_f32 v245, v245
    v_exp_f32 v246, v246
    v_exp_f32 v247, v247
    v_exp_f32 v248, v248
    v_exp_f32 v249, v249
    v_exp_f32 v250, v250
    v_exp_f32 v251, v251
    v_smfmac_f32_32x32x32_bf16 v[112:127], v[140:143], v[240:247], v7
    v_exp_f32 v252, v252
    v_exp_f32 v253, v253
    v_exp_f32 v254, v254
    v_exp_f32 v255, v255
    s_nop 1
    v_smfmac_f32_32x32x32_bf16 v[112:127], v[144:147], v[248:255], v7
    v_cvt_pk_bf16_f32 v92, v80, v81
    v_cvt_pk_bf16_f32 v93, v82, v83
    v_cvt_pk_bf16_f32 v94, v84, v85
    v_cvt_pk_bf16_f32 v95, v86, v87
    v_cvt_pk_bf16_f32 v91, v88, v89
    ds_write_b128 v169, v[92:95]
    ds_write_b64 v169, v[90:91] offset:1024
    v_cvt_pk_bf16_f32 v108, v96, v97
    v_cvt_pk_bf16_f32 v109, v98, v99
    v_cvt_pk_bf16_f32 v110, v100, v101
    v_cvt_pk_bf16_f32 v111, v102, v103
    v_cvt_pk_bf16_f32 v107, v104, v105
    ds_write_b128 v170, v[108:111]
    ds_write_b64 v170, v[106:107] offset:1024
    v_cvt_pk_bf16_f32 v124, v112, v113
    v_cvt_pk_bf16_f32 v125, v114, v115
    v_cvt_pk_bf16_f32 v126, v116, v117
    v_cvt_pk_bf16_f32 v127, v118, v119
    v_cvt_pk_bf16_f32 v123, v120, v121
    ds_write_b128 v171, v[124:127]
    ds_write_b64 v171, v[122:123] offset:1024
    s_setprio 0
    s_waitcnt vmcnt(0)
    s_cmp_lt_u32 s3, 4
    s_cbranch_scc0 L_skip_35
    v_and_b32 v252, 7, v1
    v_lshlrev_b32 v252, 2, v252
    v_add_u32 v252, 163104, v252
    s_mov_b32 s49, 0
L_spin_36:
    ds_read_b32 v253, v252
    s_waitcnt lgkmcnt(0)
    v_cmp_eq_u32 vcc, 0, v253
    s_cbranch_vccz L_got_37
    s_add_u32 s49, s49, 1
    s_cmp_lt_u32 s49, 200000
    s_cbranch_scc1 L_spin_36
L_got_37:
    ds_read_b64_tr_b16 v[128:129], v56 offset:0
    ds_read_b64_tr_b16 v[130:131], v56 offset:1280
    ds_read_b64_tr_b16 v[132:133], v56 offset:8
    ds_read_b64_tr_b16 v[134:135], v56 offset:1288
    ds_read_b64_tr_b16 v[136:137], v56 offset:16
    ds_read_b64_tr_b16 v[138:139], v56 offset:1296
    ds_read_b64_tr_b16 v[140:141], v56 offset:24
    ds_read_b64_tr_b16 v[142:143], v56 offset:1304
    ds_read_b64_tr_b16 v[144:145], v56 offset:32
    ds_read_b64_tr_b16 v[146:147], v56 offset:1312
    ds_read_b64_tr_b16 v[148:149], v56 offset:6400
    ds_read_b64_tr_b16 v[150:151], v56 offset:7680
    ds_read_b64_tr_b16 v[152:153], v56 offset:6408
    ds_read_b64_tr_b16 v[154:155], v56 offset:7688
    ds_read_b64_tr_b16 v[156:157], v56 offset:6416
    s_waitcnt lgkmcnt(13)
    ds_read_b64_tr_b16 v[158:159], v56 offset:7696
    ds_read_b64_tr_b16 v[160:161], v56 offset:6424
    s_waitcnt lgkmcnt(13)
    ds_read_b64_tr_b16 v[162:163], v56 offset:7704
    ds_read_b64_tr_b16 v[164:165], v56 offset:6432
    s_waitcnt lgkmcnt(13)
    ds_read_b64_tr_b16 v[166:167], v56 offset:7712
    ds_read_b64_tr_b16 v[192:193], v57 offset:0
    s_waitcnt lgkmcnt(13)
    ds_read_b64_tr_b16 v[194:195], v58 offset:0
    ds_read_b64_tr_b16 v[196:197], v57 offset:8
    s_waitcnt lgkmcnt(13)
    ds_read_b64_tr_b16 v[198:199], v58 offset:8
    ds_read_b64_tr_b16 v[200:201], v57 offset:16
    s_waitcnt lgkmcnt(13)
    ds_read_b64_tr_b16 v[202:203], v58 offset:16
    ds_read_b64_tr_b16 v[204:205], v57 offset:24
    s_waitcnt lgkmcnt(13)
    ds_read_b64_tr_b16 v[206:207], v58 offset:24
    ds_read_b64_tr_b16 v[208:209], v57 offset:32
    s_waitcnt lgkmcnt(13)
    ds_read_b64_tr_b16 v[210:211], v58 offset:32
    ds_read_b64_tr_b16 v[212:213], v56 offset:16000
    s_waitcnt lgkmcnt(13)
    ds_read_b64_tr_b16 v[214:215], v56 offset:17280
    ds_read_b64_tr_b16 v[216:217], v56 offset:16008
    s_waitcnt lgkmcnt(13)
    ds_read_b64_tr_b16 v[218:219], v56 offset:17288
    ds_read_b64_tr_b16 v[220:221], v56 offset:16016
    s_waitcnt lgkmcnt(13)
    ds_read_b64_tr_b16 v[222:223], v56 offset:17296
    ds_read_b64_tr_b16 v[224:225], v56 offset:16024
    s_waitcnt lgkmcnt(13)
    ds_read_b64_tr_b16 v[226:227], v56 offset:17304
    ds_read_b64_tr_b16 v[228:229], v56 offset:16032
    s_waitcnt lgkmcnt(13)
    ds_read_b64_tr_b16 v[230:231], v56 offset:17312
    ds_read_b64_tr_b16 v[232:233], v59 offset:0
    s_waitcnt lgkmcnt(13)
    ds_read_b64_tr_b16 v[234:235], v60 offset:0
    ds_read_b64_tr_b16 v[236:237], v59 offset:8
    s_waitcnt lgkmcnt(13)
    ds_read_b64_tr_b16 v[238:239], v60 offset:8
    ds_read_b64_tr_b16 v[240:241], v59 offset:16
    s_waitcnt lgkmcnt(13)
    ds_read_b64_tr_b16 v[242:243], v60 offset:16
    ds_read_b64_tr_b16 v[244:245], v59 offset:24
    s_waitcnt lgkmcnt(13)
    ds_read_b64_tr_b16 v[246:247], v60 offset:24
    ds_read_b64_tr_b16 v[248:249], v59 offset:32
    s_waitcnt lgkmcnt(13)
    ds_read_b64_tr_b16 v[250:251], v60 offset:32
L_skip_35:
    s_waitcnt lgkmcnt(0)
    s_barrier
    ds_read_b64 v[100:101], v168 offset:1024
    ds_read_b64 v[108:109], v168 offset:3072
    ds_read_b64 v[116:117], v168 offset:5120
    ds_read_b128 v[96:99], v168 offset:0
    ds_read_b128 v[104:107], v168 offset:2048
    ds_read_b128 v[112:115], v168 offset:4096
    s_waitcnt lgkmcnt(3)
    v_add_f32 v74, v74, v100
    v_add_f32 v108, v108, v116
    v_add_f32 v74, v74, v108
    v_dot2c_f32_bf16 v72, s50, v101
    v_dot2c_f32_bf16 v73, s51, v101
    v_dot2c_f32_bf16 v72, s50, v109
    v_dot2c_f32_bf16 v73, s51, v109
    v_dot2c_f32_bf16 v72, s50, v117
    v_dot2c_f32_bf16 v73, s51, v117
    v_cmp_nle_f32 vcc, 0x2b800000, v74
    s_mov_b64 s[52:53], vcc
    v_cmp_nge_f32 vcc, 0x5d800000, v74
    s_or_b64 vcc, vcc, s[52:53]
    s_cbranch_vccnz L_slow
    v_rcp_f32 v74, v74
    s_waitcnt lgkmcnt(2)
    v_dot2c_f32_bf16 v64, s50, v96
    v_dot2c_f32_bf16 v65, s51, v96
    v_dot2c_f32_bf16 v66, s50, v97
    v_dot2c_f32_bf16 v67, s51, v97
    v_dot2c_f32_bf16 v68, s50, v98
    v_dot2c_f32_bf16 v69, s51, v98
    v_dot2c_f32_bf16 v70, s50, v99
    v_dot2c_f32_bf16 v71, s51, v99
    s_waitcnt lgkmcnt(1)
    v_dot2c_f32_bf16 v64, s50, v104
    v_dot2c_f32_bf16 v65, s51, v104
    v_dot2c_f32_bf16 v66, s50, v105
    v_dot2c_f32_bf16 v67, s51, v105
    v_dot2c_f32_bf16 v68, s50, v106
    v_dot2c_f32_bf16 v69, s51, v106
    v_dot2c_f32_bf16 v70, s50, v107
    v_dot2c_f32_bf16 v71, s51, v107
    s_waitcnt lgkmcnt(0)
    v_dot2c_f32_bf16 v64, s50, v112
    v_dot2c_f32_bf16 v65, s51, v112
    v_dot2c_f32_bf16 v66, s50, v113
    v_dot2c_f32_bf16 v67, s51, v113
    v_dot2c_f32_bf16 v68, s50, v114
    v_dot2c_f32_bf16 v69, s51, v114
    v_dot2c_f32_bf16 v70, s50, v115
    v_dot2c_f32_bf16 v71, s51, v115
L_slow_done:
    v_pk_mul_f32 v[72:73], v[72:73], v[74:75] op_sel_hi:[1,0]
    v_pk_mul_f32 v[64:65], v[64:65], v[74:75] op_sel_hi:[1,0]
    v_pk_mul_f32 v[66:67], v[66:67], v[74:75] op_sel_hi:[1,0]
    v_pk_mul_f32 v[68:69], v[68:69], v[74:75] op_sel_hi:[1,0]
    v_pk_mul_f32 v[70:71], v[70:71], v[74:75] op_sel_hi:[1,0]
    v_cvt_pk_bf16_f32 v120, v64, v65
    v_cvt_pk_bf16_f32 v121, v66, v67
    v_cvt_pk_bf16_f32 v122, v68, v69
    v_cvt_pk_bf16_f32 v123, v70, v71
    v_cvt_pk_bf16_f32 v124, v72, v73
    s_cmp_eq_u32 s85, 1
    s_cbranch_scc0 L_wt_38
    buffer_store_dwordx4 v[120:123], v174, s[32:35], s80 offen
    buffer_store_dword v124, v175, s[32:35], s80 offen
    s_branch L_pub_39
L_wt_38:
    buffer_store_dwordx4 v[120:123], v174, s[32:35], s80 offen sc1
    buffer_store_dword v124, v175, s[32:35], s80 offen sc1
L_pub_39:
    s_cmp_ge_u32 s3, 4
    s_cbranch_scc0 L_skip_40
    ds_read_b64_tr_b16 v[128:129], v56 offset:0
    ds_read_b64_tr_b16 v[130:131], v56 offset:1280
    ds_read_b64_tr_b16 v[132:133], v56 offset:8
    ds_read_b64_tr_b16 v[134:135], v56 offset:1288
    ds_read_b64_tr_b16 v[136:137], v56 offset:16
    ds_read_b64_tr_b16 v[138:139], v56 offset:1296
    ds_read_b64_tr_b16 v[140:141], v56 offset:24
    ds_read_b64_tr_b16 v[142:143], v56 offset:1304
    ds_read_b64_tr_b16 v[144:145], v56 offset:32
    ds_read_b64_tr_b16 v[146:147], v56 offset:1312
    ds_read_b64_tr_b16 v[148:149], v56 offset:6400
    ds_read_b64_tr_b16 v[150:151], v56 offset:7680
    ds_read_b64_tr_b16 v[152:153], v56 offset:6408
    ds_read_b64_tr_b16 v[154:155], v56 offset:7688
    ds_read_b64_tr_b16 v[156:157], v56 offset:6416
    s_waitcnt lgkmcnt(13)
    ds_read_b64_tr_b16 v[158:159], v56 offset:7696
    ds_read_b64_tr_b16 v[160:161], v56 offset:6424
    s_waitcnt lgkmcnt(13)
    ds_read_b64_tr_b16 v[162:163], v56 offset:7704
    ds_read_b64_tr_b16 v[164:165], v56 offset:6432
    s_waitcnt lgkmcnt(13)
    ds_read_b64_tr_b16 v[166:167], v56 offset:7712
    ds_read_b64_tr_b16 v[192:193], v57 offset:0
    s_waitcnt lgkmcnt(13)
    ds_read_b64_tr_b16 v[194:195], v58 offset:0
    ds_read_b64_tr_b16 v[196:197], v57 offset:8
    s_waitcnt lgkmcnt(13)
    ds_read_b64_tr_b16 v[198:199], v58 offset:8
    ds_read_b64_tr_b16 v[200:201], v57 offset:16
    s_waitcnt lgkmcnt(13)
    ds_read_b64_tr_b16 v[202:203], v58 offset:16
    ds_read_b64_tr_b16 v[204:205], v57 offset:24
    s_waitcnt lgkmcnt(13)
    ds_read_b64_tr_b16 v[206:207], v58 offset:24
    ds_read_b64_tr_b16 v[208:209], v57 offset:32
    s_waitcnt lgkmcnt(13)
    ds_read_b64_tr_b16 v[210:211], v58 offset:32
    ds_read_b64_tr_b16 v[212:213], v56 offset:16000
    s_waitcnt lgkmcnt(13)
    ds_read_b64_tr_b16 v[214:215], v56 offset:17280
    ds_read_b64_tr_b16 v[216:217], v56 offset:16008
    s_waitcnt lgkmcnt(13)
    ds_read_b64_tr_b16 v[218:219], v56 offset:17288
    ds_read_b64_tr_b16 v[220:221], v56 offset:16016
    s_waitcnt lgkmcnt(13)
    ds_read_b64_tr_b16 v[222:223], v56 offset:17296
L_skip_40:
    s_cmp_ge_u32 s3, 4
    s_cbranch_scc0 L_skip_41
    buffer_load_dwordx4 v[64:67], v61, s[32:35], s60 offen sc1
    buffer_load_dwordx4 v[68:71], v61, s[32:35], s61 offen sc1
    buffer_load_dwordx4 v[72:75], v61, s[32:35], s62 offen sc1
    ds_read_b64_tr_b16 v[224:225], v56 offset:16024
    s_waitcnt lgkmcnt(13)
    ds_read_b64_tr_b16 v[226:227], v56 offset:17304
    ds_read_b64_tr_b16 v[228:229], v56 offset:16032
    s_waitcnt lgkmcnt(13)
    ds_read_b64_tr_b16 v[230:231], v56 offset:17312
    ds_read_b64_tr_b16 v[232:233], v59 offset:0
    s_waitcnt lgkmcnt(13)
    ds_read_b64_tr_b16 v[234:235], v60 offset:0
    ds_read_b64_tr_b16 v[236:237], v59 offset:8
    s_waitcnt lgkmcnt(13)
    ds_read_b64_tr_b16 v[238:239], v60 offset:8
    ds_read_b64_tr_b16 v[240:241], v59 offset:16
    s_waitcnt lgkmcnt(13)
    ds_read_b64_tr_b16 v[242:243], v60 offset:16
    ds_read_b64_tr_b16 v[244:245], v59 offset:24
    s_waitcnt lgkmcnt(13)
    ds_read_b64_tr_b16 v[246:247], v60 offset:24
    ds_read_b64_tr_b16 v[248:249], v59 offset:32
    s_waitcnt lgkmcnt(13)
    ds_read_b64_tr_b16 v[250:251], v60 offset:32
L_skip_41:
    s_xor_b32 s50, s6, 1
    s_mul_i32 s50, s50, 3
    s_add_u32 s50, s50, s7
    s_mul_i32 s50, s50, 5120
    s_add_u32 s50, s50, 37888
    v_add_u32 v5, s50, v4
    s_mul_i32 s50, s6, 15360
    s_add_u32 s50, s50, 32768
    v_add_u32 v6, s50, v4
    v_mul_u32_u24 v7, 80, v3
    v_add_u32 v7, 160000, v7
    s_cmp_ge_u32 s3, 4
    s_cbranch_scc0 L_skip_42
    v_lshlrev_b32 v8, 16, v176
    v_and_b32 v9, 0xffff0000, v176
    v_lshlrev_b32 v10, 16, v177
    v_and_b32 v11, 0xffff0000, v177
    v_lshlrev_b32 v12, 16, v178
    v_and_b32 v13, 0xffff0000, v178
    v_lshlrev_b32 v14, 16, v179
    v_and_b32 v15, 0xffff0000, v179
    v_lshlrev_b32 v16, 16, v180
    v_and_b32 v17, 0xffff0000, v180
    v_lshlrev_b32 v18, 16, v181
    v_and_b32 v19, 0xffff0000, v181
    v_lshlrev_b32 v20, 16, v182
    v_and_b32 v21, 0xffff0000, v182
    v_lshlrev_b32 v22, 16, v183
    v_and_b32 v23, 0xffff0000, v183
    v_lshlrev_b32 v24, 16, v184
    v_and_b32 v25, 0xffff0000, v184
    v_lshlrev_b32 v26, 16, v185
    v_and_b32 v27, 0xffff0000, v185
    s_branch L_mbj_43
L_skip_42:
    s_waitcnt lgkmcnt(10)
    v_mov_b32 v16, 0
    s_mov_b32 exec_lo, 0xfffff
    s_mov_b32 exec_hi, 0xfffff
    v_xor_b32 v176, s86, v176
    v_xor_b32 v177, s87, v177
    v_xor_b32 v178, s88, v178
    v_xor_b32 v179, s89, v179
    v_xor_b32 v180, s86, v180
    v_xor_b32 v181, s87, v181
    v_xor_b32 v182, s88, v182
    v_xor_b32 v183, s89, v183
    v_or_b32 v8, v176, v177
    v_or3_b32 v8, v8, v178, v179
    v_or3_b32 v8, v8, v180, v181
    v_or3_b32 v8, v8, v182, v183
    v_and_b32 v8, 0xff, v8
    v_cmp_ne_u32 vcc, 0, v8
    s_cbranch_vccnz L_pmretry
L_pmok:
    s_cmp_eq_u32 s6, 2
    s_cselect_b32 s52, 1.0, 0
    s_mov_b64 exec, -1
    v_permlane32_swap_b32 v176, v180
    v_permlane32_swap_b32 v177, v181
    v_permlane32_swap_b32 v178, v182
    v_permlane32_swap_b32 v179, v183
    v_pk_add_f32 v[176:177], v[176:177], v[180:181]
    v_pk_add_f32 v[178:179], v[178:179], v[182:183]
    s_nop 1
    v_permlane32_swap_b32 v176, v180
    v_permlane32_swap_b32 v177, v181
    v_permlane32_swap_b32 v178, v182
    v_permlane32_swap_b32 v179, v183
    s_mov_b64 exec, 0xfffff
    v_pk_add_f32 v[176:177], v[176:177], v[180:181]
    v_pk_add_f32 v[178:179], v[178:179], v[182:183]
    v_cvt_pk_bf16_f32 v176, 0, v176
    v_cvt_pk_bf16_f32 v177, 0, v177
    v_cvt_pk_bf16_f32 v178, 0, v178
    v_cvt_pk_bf16_f32 v179, 0, v179
    v_add_f32 v176, s52, v176
    v_add_f32 v177, s52, v177
    v_add_f32 v178, s52, v178
    v_add_f32 v179, s52, v179
    v_cvt_pk_bf16_f32 v176, 0, v176
    v_cvt_pk_bf16_f32 v177, 0, v177
    v_cvt_pk_bf16_f32 v178, 0, v178
    v_cvt_pk_bf16_f32 v179, 0, v179
    s_mul_i32 s52, s6, 320
    s_add_u32 s52, s52, 160000
    v_add_u32 v17, s52, v4
    ds_write_b128 v17, v[176:179]
    v_lshlrev_b32 v8, 16, v184
    v_and_b32 v9, 0xffff0000, v184
    v_lshlrev_b32 v10, 16, v185
    v_and_b32 v11, 0xffff0000, v185
    v_pk_mul_f32 v[12:13], v[176:177], v[8:9]
    v_pk_mul_f32 v[14:15], v[178:179], v[10:11]
    v_add_u32 v18, 161280, v4
    v_add_f32 v16, v12, v13
    v_add_f32 v19, v14, v15
    v_add_f32 v16, v16, v19
    s_cmp_eq_u32 s6, 2
    s_cbranch_scc0 L_skip_44
    ds_write_b128 v18, v[12:15]
L_skip_44:
    s_mov_b64 exec, -1
    s_nop 1
    v_add_f32_dpp v16, v16, v16 row_ror:8 row_mask:0xf bank_mask:0xf
    s_nop 1
    v_add_f32_dpp v16, v16, v16 row_ror:4 row_mask:0xf bank_mask:0xf
    s_nop 1
    v_add_f32_dpp v16, v16, v16 row_ror:2 row_mask:0xf bank_mask:0xf
    s_nop 1
    v_add_f32_dpp v16, v16, v16 row_ror:1 row_mask:0xf bank_mask:0xf
    s_nop 1
    v_readlane_b32 s52, v16, 16
    s_lshl_b32 s53, s6, 2
    s_add_u32 s53, s53, 161600
    v_mov_b32 v17, s53
    v_add_f32 v16, s52, v16
    s_mov_b64 exec, 1
    ds_write_b32 v17, v16
    s_mov_b64 exec, -1
    buffer_load_dwordx4 v[64:67], v61, s[32:35], s60 offen sc1
    buffer_load_dwordx4 v[68:71], v61, s[32:35], s61 offen sc1
    buffer_load_dwordx4 v[72:75], v61, s[32:35], s62 offen sc1
L_mbj_43:
    s_waitcnt lgkmcnt(0)
    s_barrier
    s_waitcnt vmcnt(2)
    v_max_u32 v63, v64, v65
    v_max3_u32 v63, v63, v66, v67
    v_cmp_eq_u32 vcc, -1, v63
    s_cbranch_vccnz L_oretry_45
L_oback_46:
    v_mfma_f32_16x16x32_bf16 v[252:255], v[128:131], v[64:67], 0
    buffer_load_dwordx4 v[76:79], v61, s[32:35], s63 offen sc1
    v_mfma_f32_16x16x32_bf16 v[124:127], v[132:135], v[64:67], 0
    v_mfma_f32_16x16x32_bf16 v[188:191], v[136:139], v[64:67], 0
    v_mfma_f32_16x16x32_bf16 v[168:171], v[140:143], v[64:67], 0
    s_waitcnt vmcnt(2)
    v_max_u32 v63, v68, v69
    v_max3_u32 v63, v63, v70, v71
    v_cmp_eq_u32 vcc, -1, v63
    v_mfma_f32_16x16x32_bf16 v[172:175], v[144:147], v[64:67], 0
    s_cbranch_vccnz L_oretry_47
L_oback_48:
    v_mfma_f32_16x16x32_bf16 v[252:255], v[148:151], v[68:71], v[252:255]
    buffer_load_dwordx4 v[80:83], v61, s[32:35], s64 offen sc1
    v_mfma_f32_16x16x32_bf16 v[124:127], v[152:155], v[68:71], v[124:127]
    v_mfma_f32_16x16x32_bf16 v[188:191], v[156:159], v[68:71], v[188:191]
    v_mfma_f32_16x16x32_bf16 v[168:171], v[160:163], v[68:71], v[168:171]
    s_waitcnt vmcnt(2)
    v_max_u32 v63, v72, v73
    v_max3_u32 v63, v63, v74, v75
    v_cmp_eq_u32 vcc, -1, v63
    v_mfma_f32_16x16x32_bf16 v[172:175], v[164:167], v[68:71], v[172:175]
    s_cbranch_vccnz L_oretry_49
L_oback_50:
    v_mfma_f32_16x16x32_bf16 v[252:255], v[192:195], v[72:75], v[252:255]
    buffer_load_dwordx4 v[84:87], v61, s[32:35], s65 offen sc1
    v_mfma_f32_16x16x32_bf16 v[124:127], v[196:199], v[72:75], v[124:127]
    v_mfma_f32_16x16x32_bf16 v[188:191], v[200:203], v[72:75], v[188:191]
    v_mfma_f32_16x16x32_bf16 v[168:171], v[204:207], v[72:75], v[168:171]
    s_waitcnt vmcnt(2)
    v_max_u32 v63, v76, v77
    v_max3_u32 v63, v63, v78, v79
    v_cmp_eq_u32 vcc, -1, v63
    v_mfma_f32_16x16x32_bf16 v[172:175], v[208:211], v[72:75], v[172:175]
    s_cbranch_vccnz L_oretry_51
L_oback_52:
    v_mfma_f32_16x16x32_bf16 v[252:255], v[212:215], v[76:79], v[252:255]
    buffer_load_dwordx4 v[88:91], v61, s[32:35], s66 offen sc1
    v_mfma_f32_16x16x32_bf16 v[124:127], v[216:219], v[76:79], v[124:127]
    v_mfma_f32_16x16x32_bf16 v[188:191], v[220:223], v[76:79], v[188:191]
    v_mfma_f32_16x16x32_bf16 v[168:171], v[224:227], v[76:79], v[168:171]
    s_waitcnt vmcnt(2)
    v_max_u32 v63, v80, v81
    v_max3_u32 v63, v63, v82, v83
    v_cmp_eq_u32 vcc, -1, v63
    v_mfma_f32_16x16x32_bf16 v[172:175], v[228:231], v[76:79], v[172:175]
    s_cbranch_vccnz L_oretry_53
L_oback_54:
    v_mfma_f32_16x16x32_bf16 v[252:255], v[232:235], v[80:83], v[252:255]
    buffer_load_dwordx4 v[92:95], v61, s[32:35], s67 offen sc1
    v_mfma_f32_16x16x32_bf16 v[124:127], v[236:239], v[80:83], v[124:127]
    v_mfma_f32_16x16x32_bf16 v[188:191], v[240:243], v[80:83], v[188:191]
    v_mfma_f32_16x16x32_bf16 v[168:171], v[244:247], v[80:83], v[168:171]
    s_waitcnt vmcnt(2)
    v_max_u32 v63, v84, v85
    v_max3_u32 v63, v63, v86, v87
    v_cmp_eq_u32 vcc, -1, v63
    v_mfma_f32_16x16x32_bf16 v[172:175], v[248:251], v[80:83], v[172:175]
    s_cbranch_vccnz L_oretry_55
L_oback_56:
    v_mfma_f32_16x16x32_bf16 v[104:107], v[128:131], v[84:87], 0
    buffer_load_dwordx4 v[96:99], v61, s[32:35], s68 offen sc1
    v_mfma_f32_16x16x32_bf16 v[108:111], v[132:135], v[84:87], 0
    v_mfma_f32_16x16x32_bf16 v[112:115], v[136:139], v[84:87], 0
    v_mfma_f32_16x16x32_bf16 v[116:119], v[140:143], v[84:87], 0
    ds_write_b128 v5, v[252:255] offset:0
    s_waitcnt vmcnt(2)
    v_max_u32 v63, v88, v89
    v_max3_u32 v63, v63, v90, v91
    v_cmp_eq_u32 vcc, -1, v63
    v_mfma_f32_16x16x32_bf16 v[120:123], v[144:147], v[84:87], 0
    ds_write_b128 v5, v[124:127] offset:1024
    s_cbranch_vccnz L_oretry_57
L_oback_58:
    s_cmp_ge_u32 s3, 4
    s_cbranch_scc0 L_helper2_59
    v_mfma_f32_16x16x32_bf16 v[104:107], v[148:151], v[88:91], v[104:107]
    buffer_load_dwordx4 v[100:103], v61, s[32:35], s69 offen sc1
    v_mfma_f32_16x16x32_bf16 v[108:111], v[152:155], v[88:91], v[108:111]
    ds_write_b128 v5, v[188:191] offset:2048
    v_mfma_f32_16x16x32_bf16 v[112:115], v[156:159], v[88:91], v[112:115]
    v_mfma_f32_16x16x32_bf16 v[116:119], v[160:163], v[88:91], v[116:119]
    ds_write_b128 v5, v[168:171] offset:3072
    s_waitcnt vmcnt(2)
    v_max_u32 v63, v92, v93
    v_max3_u32 v63, v63, v94, v95
    v_cmp_eq_u32 vcc, -1, v63
    v_mfma_f32_16x16x32_bf16 v[120:123], v[164:167], v[88:91], v[120:123]
    ds_write_b128 v5, v[172:175] offset:4096
    s_cbranch_vccnz L_oretry_60
L_oback_61:
    v_mfma_f32_16x16x32_bf16 v[104:107], v[192:195], v[92:95], v[104:107]
    ds_read_b128 v[128:131], v7 offset:0
    v_mfma_f32_16x16x32_bf16 v[108:111], v[196:199], v[92:95], v[108:111]
    ds_read_b128 v[132:135], v7 offset:16
    v_mfma_f32_16x16x32_bf16 v[112:115], v[200:203], v[92:95], v[112:115]
    ds_read_b128 v[136:139], v7 offset:32
    v_mfma_f32_16x16x32_bf16 v[116:119], v[204:207], v[92:95], v[116:119]
    ds_read_b128 v[140:143], v7 offset:48
    s_waitcnt vmcnt(1)
    v_max_u32 v63, v96, v97
    v_max3_u32 v63, v63, v98, v99
    v_cmp_eq_u32 vcc, -1, v63
    v_mfma_f32_16x16x32_bf16 v[120:123], v[208:211], v[92:95], v[120:123]
    ds_read_b128 v[144:147], v7 offset:64
    s_cbranch_vccnz L_oretry_62
L_oback_63:
    v_mfma_f32_16x16x32_bf16 v[104:107], v[212:215], v[96:99], v[104:107]
    ds_read_b128 v[148:151], v7 offset:1280
    v_mfma_f32_16x16x32_bf16 v[108:111], v[216:219], v[96:99], v[108:111]
    ds_read_b128 v[152:155], v7 offset:1296
    v_mfma_f32_16x16x32_bf16 v[112:115], v[220:223], v[96:99], v[112:115]
    ds_read_b128 v[156:159], v7 offset:1312
    v_mfma_f32_16x16x32_bf16 v[116:119], v[224:227], v[96:99], v[116:119]
    ds_read_b128 v[160:163], v7 offset:1328
    s_waitcnt vmcnt(0)
    v_max_u32 v63, v100, v101
    v_max3_u32 v63, v63, v102, v103
    v_cmp_eq_u32 vcc, -1, v63
    v_mfma_f32_16x16x32_bf16 v[120:123], v[228:231], v[96:99], v[120:123]
    ds_read_b128 v[164:167], v7 offset:1344
    s_cbranch_vccnz L_oretry_64
L_oback_65:
    v_mfma_f32_16x16x32_bf16 v[104:107], v[232:235], v[100:103], v[104:107]
    s_waitcnt lgkmcnt(10)
    v_mov_b32 v5, 161600
    v_mfma_f32_16x16x32_bf16 v[108:111], v[236:239], v[100:103], v[108:111]
    ds_read_b128 v[176:179], v5
    s_lshl_b32 s50, s4, 13
    v_mfma_f32_16x16x32_bf16 v[112:115], v[240:243], v[100:103], v[112:115]
    s_lshl_b32 s51, s6, 8
    s_add_u32 s50, s50, s51
    s_add_u32 s50, s50, 196608
    v_mfma_f32_16x16x32_bf16 v[116:119], v[244:247], v[100:103], v[116:119]
    s_lshl_b32 s51, s5, 10
    s_add_u32 s51, s51, s50
    v_mfma_f32_16x16x32_bf16 v[120:123], v[248:251], v[100:103], v[120:123]
    s_add_u32 s52, s50, 4096
    s_mov_b32 vcc_lo, 0xaaaaaaaa
    s_mov_b32 vcc_hi, 0xaaaaaaaa
    s_waitcnt lgkmcnt(0)
    s_barrier
    ds_read_b128 v[192:195], v6 offset:0
    ds_read_b128 v[196:199], v6 offset:5120
    ds_read_b128 v[200:203], v6 offset:10240
    ds_read_b128 v[204:207], v6 offset:1024
    ds_read_b128 v[208:211], v6 offset:6144
    ds_read_b128 v[212:215], v6 offset:11264
    ds_read_b128 v[216:219], v6 offset:2048
    ds_read_b128 v[220:223], v6 offset:7168
    ds_read_b128 v[224:227], v6 offset:12288
    ds_read_b128 v[228:231], v6 offset:3072
    ds_read_b128 v[232:235], v6 offset:8192
    ds_read_b128 v[236:239], v6 offset:13312
    ds_read_b128 v[240:243], v6 offset:4096
    ds_read_b128 v[244:247], v6 offset:9216
    ds_read_b128 v[248:251], v6 offset:14336
    v_cndmask_b32 v67, v178, v177, vcc
    v_mul_f32 v67, 0x3e800000, v67
    s_waitcnt lgkmcnt(12)
    v_pk_add_f32 v[192:193], v[192:193], v[196:197]
    v_pk_add_f32 v[194:195], v[194:195], v[198:199]
    v_pk_add_f32 v[104:105], v[104:105], v[200:201]
    v_pk_add_f32 v[106:107], v[106:107], v[202:203]
    v_pk_add_f32 v[104:105], v[104:105], v[192:193]
    v_pk_add_f32 v[106:107], v[106:107], v[194:195]
    v_pk_fma_f32 v[8:9], v[104:105], v[128:129], v[8:9]
    v_pk_fma_f32 v[10:11], v[106:107], v[130:131], v[10:11]
    s_waitcnt lgkmcnt(9)
    v_pk_add_f32 v[204:205], v[204:205], v[208:209]
    v_pk_add_f32 v[206:207], v[206:207], v[210:211]
    v_pk_add_f32 v[108:109], v[108:109], v[212:213]
    v_pk_add_f32 v[110:111], v[110:111], v[214:215]
    v_pk_add_f32 v[108:109], v[108:109], v[204:205]
    v_pk_add_f32 v[110:111], v[110:111], v[206:207]
    v_pk_fma_f32 v[12:13], v[108:109], v[132:133], v[12:13]
    v_pk_fma_f32 v[14:15], v[110:111], v[134:135], v[14:15]
    s_waitcnt lgkmcnt(6)
    v_pk_add_f32 v[216:217], v[216:217], v[220:221]
    v_pk_add_f32 v[218:219], v[218:219], v[222:223]
    v_pk_add_f32 v[112:113], v[112:113], v[224:225]
    v_pk_add_f32 v[114:115], v[114:115], v[226:227]
    v_pk_add_f32 v[112:113], v[112:113], v[216:217]
    v_pk_add_f32 v[114:115], v[114:115], v[218:219]
    v_pk_fma_f32 v[16:17], v[112:113], v[136:137], v[16:17]
    v_pk_fma_f32 v[18:19], v[114:115], v[138:139], v[18:19]
    s_waitcnt lgkmcnt(3)
    v_pk_add_f32 v[228:229], v[228:229], v[232:233]
    v_pk_add_f32 v[230:231], v[230:231], v[234:235]
    v_pk_add_f32 v[116:117], v[116:117], v[236:237]
    v_pk_add_f32 v[118:119], v[118:119], v[238:239]
    v_pk_add_f32 v[116:117], v[116:117], v[228:229]
    v_pk_add_f32 v[118:119], v[118:119], v[230:231]
    v_pk_fma_f32 v[20:21], v[116:117], v[140:141], v[20:21]
    v_pk_fma_f32 v[22:23], v[118:119], v[142:143], v[22:23]
    s_waitcnt lgkmcnt(0)
    v_pk_add_f32 v[240:241], v[240:241], v[244:245]
    v_pk_add_f32 v[242:243], v[242:243], v[246:247]
    v_pk_add_f32 v[120:121], v[120:121], v[248:249]
    v_pk_add_f32 v[122:123], v[122:123], v[250:251]
    v_pk_add_f32 v[120:121], v[120:121], v[240:241]
    v_pk_add_f32 v[122:123], v[122:123], v[242:243]
    v_pk_fma_f32 v[24:25], v[120:121], v[144:145], v[24:25]
    v_pk_fma_f32 v[26:27], v[122:123], v[146:147], v[26:27]
    v_pk_add_f32 v[72:73], v[8:9], v[10:11]
    v_pk_mul_f32 v[74:75], v[8:9], v[8:9]
    v_pk_mul_f32 v[76:77], v[8:9], v[148:149]
    v_pk_fma_f32 v[74:75], v[10:11], v[10:11], v[74:75]
    v_pk_fma_f32 v[76:77], v[10:11], v[150:151], v[76:77]
    v_pk_add_f32 v[72:73], v[72:73], v[12:13]
    v_pk_fma_f32 v[74:75], v[12:13], v[12:13], v[74:75]
    v_pk_fma_f32 v[76:77], v[12:13], v[152:153], v[76:77]
    v_pk_add_f32 v[72:73], v[72:73], v[14:15]
    v_pk_fma_f32 v[74:75], v[14:15], v[14:15], v[74:75]
    v_pk_fma_f32 v[76:77], v[14:15], v[154:155], v[76:77]
    v_pk_add_f32 v[72:73], v[72:73], v[16:17]
    v_pk_fma_f32 v[74:75], v[16:17], v[16:17], v[74:75]
    v_pk_fma_f32 v[76:77], v[16:17], v[156:157], v[76:77]
    v_pk_add_f32 v[72:73], v[72:73], v[18:19]
    v_pk_fma_f32 v[74:75], v[18:19], v[18:19], v[74:75]
    v_pk_fma_f32 v[76:77], v[18:19], v[158:159], v[76:77]
    v_pk_add_f32 v[72:73], v[72:73], v[20:21]
    v_pk_fma_f32 v[74:75], v[20:21], v[20:21], v[74:75]
    v_pk_fma_f32 v[76:77], v[20:21], v[160:161], v[76:77]
    v_pk_add_f32 v[72:73], v[72:73], v[22:23]
    v_pk_fma_f32 v[74:75], v[22:23], v[22:23], v[74:75]
    v_pk_fma_f32 v[76:77], v[22:23], v[162:163], v[76:77]
    v_pk_add_f32 v[72:73], v[72:73], v[24:25]
    v_pk_fma_f32 v[74:75], v[24:25], v[24:25], v[74:75]
    v_pk_fma_f32 v[76:77], v[24:25], v[164:165], v[76:77]
    v_pk_add_f32 v[72:73], v[72:73], v[26:27]
    v_pk_fma_f32 v[74:75], v[26:27], v[26:27], v[74:75]
    v_pk_fma_f32 v[76:77], v[26:27], v[166:167], v[76:77]
    v_add_f32 v64, v72, v73
    v_add_f32 v65, v74, v75
    v_add_f32 v66, v76, v77
    v_lshlrev_b32 v68, 4, v2
    v_lshl_add_u32 v68, v3, 2, v68
    v_permlane32_swap_b32 v64, v66
    v_permlane32_swap_b32 v65, v67
    v_add_f32 v64, v64, v66
    v_add_f32 v65, v65, v67
    s_nop 1
    v_permlane16_swap_b32 v64, v65
    v_add_f32 v69, v64, v65
    s_cmp_eq_u32 s85, 1
    s_cbranch_scc0 L_wt_66
    buffer_store_dword v69, v68, s[32:35], s51 offen
    s_branch L_pub_67
L_wt_66:
    buffer_store_dword v69, v68, s[32:35], s51 offen sc1
L_pub_67:
    s_cmp_lt_u32 s2, 216
    s_cbranch_scc0 L_skip_68
    s_mul_i32 s56, s7, 10304
    s_mul_i32 s57, s6, 2560
    s_add_u32 s56, s56, s57
    v_lshrrev_b32 v124, 5, v1
    v_lshl_add_u32 v124, v124, 4, v2
    v_lshl_add_u32 v124, v124, 4, s56
    s_mov_b32 exec_lo, 0xffff
    s_mov_b32 exec_hi, 0xffff
    ds_write_b128 v124, v[28:31] offset:0
    ds_write_b128 v124, v[32:35] offset:512
    ds_write_b128 v124, v[36:39] offset:1024
    ds_write_b128 v124, v[40:43] offset:1536
    ds_write_b128 v124, v[44:47] offset:2048
    s_mov_b64 exec, -1
L_skip_68:
    buffer_load_dwordx4 v[72:75], v61, s[32:35], s50 offen sc1
    buffer_load_dwordx4 v[76:79], v61, s[32:35], s52 offen sc1
    s_waitcnt lgkmcnt(0)
    ds_read_b128 v[128:131], v7 offset:640
    ds_read_b128 v[132:135], v7 offset:656
    ds_read_b128 v[136:139], v7 offset:672
    ds_read_b128 v[140:143], v7 offset:688
    ds_read_b128 v[144:147], v7 offset:704
    ds_read_b128 v[148:151], v7 offset:320
    ds_read_b128 v[152:155], v7 offset:336
    ds_read_b128 v[156:159], v7 offset:352
    ds_read_b128 v[160:163], v7 offset:368
    ds_read_b128 v[164:167], v7 offset:384
    ds_read_b128 v[168:171], v7 offset:960
    ds_read_b128 v[172:175], v7 offset:976
    ds_read_b128 v[176:179], v7 offset:992
    ds_read_b128 v[180:183], v7 offset:1008
    ds_read_b128 v[184:187], v7 offset:1024
    s_lshl_b32 s53, s4, 6
    s_lshl_b32 s54, s6, 4
    s_add_u32 s53, s53, s54
    s_sub_u32 s53, 2047, s53
    v_sub_u32 v80, s53, v2
    s_lshl_b32 s54, s6, 2
    s_add_u32 s54, s54, 161808
    v_mov_b32 v81, s54
    v_mov_b32 v82, 161792
    v_mul_u32_u24 v83, 40, v3
    s_waitcnt vmcnt(0)
    v_max_u32 v64, v72, v73
    v_max3_u32 v64, v64, v74, v75
    v_max3_u32 v64, v64, v76, v77
    v_max3_u32 v64, v64, v78, v79
    v_cmp_eq_u32 vcc, -1, v64
    s_cbranch_vccnz L_stretry
L_stok:
    v_pk_add_f32 v[64:65], v[72:73], v[76:77]
    v_pk_add_f32 v[66:67], v[74:75], v[78:79]
    v_mov_b32 v72, v64
    v_mov_b32 v73, v65
    v_mov_b32 v74, v66
    v_mov_b32 v75, v67
    s_nop 1
    v_permlane32_swap_b32 v64, v72
    v_permlane32_swap_b32 v65, v73
    v_permlane32_swap_b32 v66, v74
    v_permlane32_swap_b32 v67, v75
    v_add_f32 v64, v64, v72
    v_add_f32 v65, v65, v73
    v_add_f32 v66, v66, v74
    v_add_f32 v67, v67, v75
    v_mov_b32 v72, v64
    v_mov_b32 v73, v65
    v_mov_b32 v74, v66
    v_mov_b32 v75, v67
    s_nop 1
    v_permlane16_swap_b32 v64, v72
    v_permlane16_swap_b32 v65, v73
    v_permlane16_swap_b32 v66, v74
    v_permlane16_swap_b32 v67, v75
    v_add_f32 v64, v64, v72
    v_add_f32 v65, v65, v73
    v_add_f32 v66, v66, v74
    v_add_f32 v67, v67, v75
    v_mul_f32 v64, 0x3acccccd, v64
    v_mul_f32 v65, 0x3acccccd, v65
    v_mov_b32_dpp v68, v67 quad_perm:[0,0,2,2] row_mask:0xf bank_mask:0xf
    v_mov_b32_dpp v69, v67 quad_perm:[1,1,3,3] row_mask:0xf bank_mask:0xf
    v_fma_f32 v65, -v64, v64, v65
    v_max_f32 v65, 0, v65
    v_add_f32 v65, 0x3727c5ac, v65
    v_rsq_f32 v70, v65
    v_fma_f32 v66, -v64, v68, v66
    v_fma_f32 v66, v66, v70, v69
    v_mul_f32 v64, v64, v70
    v_ashrrev_i32 v67, 31, v66
    v_or_b32 v67, 0x80000000, v67
    v_xor_b32 v66, v66, v67
    v_and_b32 v66, 0xfffff800, v66
    v_or_b32 v66, v66, v80
    v_min_u32 v66, -2, v66
    s_nop 1
    v_max_u32_dpp v67, v66, v66 row_ror:8 row_mask:0xf bank_mask:0xf
    s_nop 1
    v_max_u32_dpp v67, v67, v67 row_ror:4 row_mask:0xf bank_mask:0xf
    s_nop 1
    v_max_u32_dpp v67, v67, v67 row_ror:2 row_mask:0xf bank_mask:0xf
    s_nop 1
    v_max_u32_dpp v67, v67, v67 row_ror:1 row_mask:0xf bank_mask:0xf
    s_mov_b64 exec, 1
    ds_write_b32 v81, v67
    s_mov_b64 exec, -1
    s_waitcnt lgkmcnt(0)
    s_barrier
    ds_read_b128 v[72:75], v82 offset:16
    v_pk_fma_f32 v[84:85], v[8:9], v[70:71], v[64:65] op_sel_hi:[1,0,0] neg_lo:[0,0,1] neg_hi:[0,0,1]
    v_pk_fma_f32 v[86:87], v[10:11], v[70:71], v[64:65] op_sel_hi:[1,0,0] neg_lo:[0,0,1] neg_hi:[0,0,1]
    v_pk_fma_f32 v[88:89], v[12:13], v[70:71], v[64:65] op_sel_hi:[1,0,0] neg_lo:[0,0,1] neg_hi:[0,0,1]
    v_pk_fma_f32 v[90:91], v[14:15], v[70:71], v[64:65] op_sel_hi:[1,0,0] neg_lo:[0,0,1] neg_hi:[0,0,1]
    v_pk_fma_f32 v[92:93], v[16:17], v[70:71], v[64:65] op_sel_hi:[1,0,0] neg_lo:[0,0,1] neg_hi:[0,0,1]
    v_pk_fma_f32 v[94:95], v[18:19], v[70:71], v[64:65] op_sel_hi:[1,0,0] neg_lo:[0,0,1] neg_hi:[0,0,1]
    v_pk_fma_f32 v[96:97], v[20:21], v[70:71], v[64:65] op_sel_hi:[1,0,0] neg_lo:[0,0,1] neg_hi:[0,0,1]
    v_pk_fma_f32 v[98:99], v[22:23], v[70:71], v[64:65] op_sel_hi:[1,0,0] neg_lo:[0,0,1] neg_hi:[0,0,1]
    v_pk_fma_f32 v[100:101], v[24:25], v[70:71], v[64:65] op_sel_hi:[1,0,0] neg_lo:[0,0,1] neg_hi:[0,0,1]
    v_pk_fma_f32 v[102:103], v[26:27], v[70:71], v[64:65] op_sel_hi:[1,0,0] neg_lo:[0,0,1] neg_hi:[0,0,1]
    v_pk_fma_f32 v[84:85], v[84:85], v[128:129], v[148:149]
    v_pk_fma_f32 v[86:87], v[86:87], v[130:131], v[150:151]
    v_pk_fma_f32 v[88:89], v[88:89], v[132:133], v[152:153]
    v_pk_fma_f32 v[90:91], v[90:91], v[134:135], v[154:155]
    v_pk_fma_f32 v[92:93], v[92:93], v[136:137], v[156:157]
    v_pk_fma_f32 v[94:95], v[94:95], v[138:139], v[158:159]
    v_pk_fma_f32 v[96:97], v[96:97], v[140:141], v[160:161]
    v_pk_fma_f32 v[98:99], v[98:99], v[142:143], v[162:163]
    v_pk_fma_f32 v[100:101], v[100:101], v[144:145], v[164:165]
    v_pk_fma_f32 v[102:103], v[102:103], v[146:147], v[166:167]
    s_waitcnt lgkmcnt(0)
    v_max_u32 v72, v72, v73
    v_max3_u32 v72, v72, v74, v75
    v_cmp_eq_u32 s[94:95], v66, v72
    v_cvt_pk_bf16_f32 v104, v84, v85
    v_cvt_pk_bf16_f32 v105, v86, v87
    v_cvt_pk_bf16_f32 v106, v88, v89
    v_cvt_pk_bf16_f32 v107, v90, v91
    v_cvt_pk_bf16_f32 v108, v92, v93
    v_cvt_pk_bf16_f32 v109, v94, v95
    v_cvt_pk_bf16_f32 v110, v96, v97
    v_cvt_pk_bf16_f32 v111, v98, v99
    v_cvt_pk_bf16_f32 v112, v100, v101
    v_cvt_pk_bf16_f32 v113, v102, v103
    s_lshl_b32 s52, s4, 11
    s_lshl_b32 s53, s5, 8
    s_add_u32 s52, s52, s53
    s_add_u32 s52, s52, 114688
    s_cmp_eq_u64 s[94:95], 0
    s_cbranch_scc1 L_norow_69
    s_mov_b64 exec, s[94:95]
    buffer_store_dwordx4 v[104:107], v83, s[32:35], s52 offen sc1
    buffer_store_dwordx4 v[108:111], v83, s[32:35], s52 offen offset:16 sc1
    buffer_store_dwordx2 v[112:113], v83, s[32:35], s52 offen offset:32 sc1
    s_mov_b64 exec, -1
L_norow_69:
    v_pk_fma_f32 v[8:9], v[84:85], v[168:169], v[8:9]
    v_pk_fma_f32 v[10:11], v[86:87], v[170:171], v[10:11]
    v_pk_fma_f32 v[12:13], v[88:89], v[172:173], v[12:13]
    v_pk_fma_f32 v[14:15], v[90:91], v[174:175], v[14:15]
    v_pk_fma_f32 v[16:17], v[92:93], v[176:177], v[16:17]
    v_pk_fma_f32 v[18:19], v[94:95], v[178:179], v[18:19]
    v_pk_fma_f32 v[20:21], v[96:97], v[180:181], v[20:21]
    v_pk_fma_f32 v[22:23], v[98:99], v[182:183], v[22:23]
    v_pk_fma_f32 v[24:25], v[100:101], v[184:185], v[24:25]
    v_pk_fma_f32 v[26:27], v[102:103], v[186:187], v[26:27]
    v_cvt_pk_bf16_f32 v114, v8, v9
    v_cvt_pk_bf16_f32 v115, v10, v11
    v_cvt_pk_bf16_f32 v116, v12, v13
    v_cvt_pk_bf16_f32 v117, v14, v15
    v_cvt_pk_bf16_f32 v118, v16, v17
    v_cvt_pk_bf16_f32 v119, v18, v19
    v_cvt_pk_bf16_f32 v120, v20, v21
    v_cvt_pk_bf16_f32 v121, v22, v23
    v_cvt_pk_bf16_f32 v122, v24, v25
    v_cvt_pk_bf16_f32 v123, v26, v27
    s_cmp_ge_u32 s2, 216
    s_cbranch_scc0 L_skip_70
    s_mul_i32 s56, s3, 7168
    v_add_u32 v252, s56, v4
    s_cmp_eq_u32 s3, 7
    s_cbranch_scc0 L_skip_71
    v_mov_b32 v48, 0
    v_mov_b32 v49, 0
    v_mov_b32 v50, 0
    v_mov_b32 v51, 0
    v_mov_b32 v52, 0
    v_mov_b32 v53, 0
    v_mov_b32 v54, 0
    v_mov_b32 v55, 0
L_skip_71:
    ds_write_b128 v252, v[28:31] offset:0
    ds_write_b128 v252, v[32:35] offset:1024
    ds_write_b128 v252, v[36:39] offset:2048
    ds_write_b128 v252, v[40:43] offset:3072
    ds_write_b128 v252, v[44:47] offset:4096
    ds_write_b128 v252, v[48:51] offset:5120
    ds_write_b128 v252, v[52:55] offset:6144
    v_bfe_u32 v253, v1, 2, 2
    v_lshl_add_u32 v253, v3, 3, v253
    v_lshlrev_b32 v253, 5, v253
    v_and_b32 v254, 3, v1
    v_lshl_add_u32 v253, v254, 3, v253
    v_add_u32 v253, s56, v253
    s_waitcnt lgkmcnt(0)
    ds_read_b64_tr_b16 v[224:225], v253 offset:0
    ds_read_b64_tr_b16 v[226:227], v253 offset:128
    ds_read_b64_tr_b16 v[228:229], v253 offset:1024
    ds_read_b64_tr_b16 v[230:231], v253 offset:1152
    ds_read_b64_tr_b16 v[232:233], v253 offset:2048
    ds_read_b64_tr_b16 v[234:235], v253 offset:2176
    ds_read_b64_tr_b16 v[236:237], v253 offset:3072
    ds_read_b64_tr_b16 v[238:239], v253 offset:3200
    ds_read_b64_tr_b16 v[240:241], v253 offset:4096
    ds_read_b64_tr_b16 v[242:243], v253 offset:4224
    ds_read_b64_tr_b16 v[244:245], v253 offset:5120
    ds_read_b64_tr_b16 v[246:247], v253 offset:5248
    ds_read_b64_tr_b16 v[248:249], v253 offset:6144
    ds_read_b64_tr_b16 v[250:251], v253 offset:6272
    s_waitcnt lgkmcnt(0)
L_skip_70:
    s_barrier
    ds_read_b32 v73, v82
    s_waitcnt lgkmcnt(0)
    v_cmp_eq_u32 vcc, v73, v66
    s_cbranch_vccz L_nowin_72
    s_mov_b64 exec, vcc
    v_lshlrev_b32 v83, 1, v83
    s_lshl_b32 s52, s5, 10
    s_add_u32 s52, s52, 106496
    buffer_store_dwordx4 v[8:11], v83, s[32:35], s52 offen offset:0 sc1
    buffer_store_dwordx4 v[168:171], v83, s[32:35], s52 offen offset:512 sc1
    buffer_store_dwordx4 v[12:15], v83, s[32:35], s52 offen offset:16 sc1
    buffer_store_dwordx4 v[172:175], v83, s[32:35], s52 offen offset:528 sc1
    buffer_store_dwordx4 v[16:19], v83, s[32:35], s52 offen offset:32 sc1
    buffer_store_dwordx4 v[176:179], v83, s[32:35], s52 offen offset:544 sc1
    buffer_store_dwordx4 v[20:23], v83, s[32:35], s52 offen offset:48 sc1
    buffer_store_dwordx4 v[180:183], v83, s[32:35], s52 offen offset:560 sc1
    buffer_store_dwordx4 v[24:27], v83, s[32:35], s52 offen offset:64 sc1
    buffer_store_dwordx4 v[184:187], v83, s[32:35], s52 offen offset:576 sc1
L_nowin_72:
    s_cmp_lt_u32 s2, 216
    s_cbranch_scc0 L_skip_74
    s_barrier
L_skip_74:
    s_not_b64 exec, vcc
    buffer_store_dwordx4 v[114:117], v62, s[36:39], s82 offen
    buffer_store_dwordx4 v[118:121], v62, s[36:39], s82 offen offset:16
    buffer_store_dwordx2 v[122:123], v62, s[36:39], s82 offen offset:32
    s_mov_b64 exec, -1
    s_branch L_tail_73
L_helper2_59:
    v_mfma_f32_16x16x32_bf16 v[104:107], v[148:151], v[88:91], v[104:107]
    buffer_load_dwordx4 v[100:103], v61, s[32:35], s69 offen sc1
    v_mfma_f32_16x16x32_bf16 v[108:111], v[152:155], v[88:91], v[108:111]
    ds_write_b128 v5, v[188:191] offset:2048
    v_mfma_f32_16x16x32_bf16 v[112:115], v[156:159], v[88:91], v[112:115]
    v_mfma_f32_16x16x32_bf16 v[116:119], v[160:163], v[88:91], v[116:119]
    ds_write_b128 v5, v[168:171] offset:3072
    s_waitcnt vmcnt(2)
    v_max_u32 v63, v92, v93
    v_max3_u32 v63, v63, v94, v95
    v_cmp_eq_u32 vcc, -1, v63
    v_mfma_f32_16x16x32_bf16 v[120:123], v[164:167], v[88:91], v[120:123]
    ds_write_b128 v5, v[172:175] offset:4096
    s_cbranch_vccnz L_oretry_75
L_oback_76:
    v_mfma_f32_16x16x32_bf16 v[104:107], v[192:195], v[92:95], v[104:107]
    v_mfma_f32_16x16x32_bf16 v[108:111], v[196:199], v[92:95], v[108:111]
    v_mfma_f32_16x16x32_bf16 v[112:115], v[200:203], v[92:95], v[112:115]
    v_mfma_f32_16x16x32_bf16 v[116:119], v[204:207], v[92:95], v[116:119]
    s_waitcnt vmcnt(1)
    v_max_u32 v63, v96, v97
    v_max3_u32 v63, v63, v98, v99
    v_cmp_eq_u32 vcc, -1, v63
    v_mfma_f32_16x16x32_bf16 v[120:123], v[208:211], v[92:95], v[120:123]
    s_cbranch_vccnz L_oretry_77
L_oback_78:
    v_mfma_f32_16x16x32_bf16 v[104:107], v[212:215], v[96:99], v[104:107]
    v_mfma_f32_16x16x32_bf16 v[108:111], v[216:219], v[96:99], v[108:111]
    v_mfma_f32_16x16x32_bf16 v[112:115], v[220:223], v[96:99], v[112:115]
    v_mfma_f32_16x16x32_bf16 v[116:119], v[224:227], v[96:99], v[116:119]
    s_waitcnt vmcnt(0)
    v_max_u32 v63, v100, v101
    v_max3_u32 v63, v63, v102, v103
    v_cmp_eq_u32 vcc, -1, v63
    v_mfma_f32_16x16x32_bf16 v[120:123], v[228:231], v[96:99], v[120:123]
    s_cbranch_vccnz L_oretry_79
L_oback_80:
    v_mfma_f32_16x16x32_bf16 v[104:107], v[232:235], v[100:103], v[104:107]
    v_mfma_f32_16x16x32_bf16 v[108:111], v[236:239], v[100:103], v[108:111]
    v_mfma_f32_16x16x32_bf16 v[112:115], v[240:243], v[100:103], v[112:115]
    v_mfma_f32_16x16x32_bf16 v[116:119], v[244:247], v[100:103], v[116:119]
    v_mfma_f32_16x16x32_bf16 v[120:123], v[248:251], v[100:103], v[120:123]
    s_nop 3
    ds_write_b128 v6, v[104:107] offset:0
    ds_write_b128 v6, v[108:111] offset:1024
    ds_write_b128 v6, v[112:115] offset:2048
    ds_write_b128 v6, v[116:119] offset:3072
    ds_write_b128 v6, v[120:123] offset:4096
    s_setprio 0
    s_waitcnt lgkmcnt(0)
    s_barrier
    s_cmp_lt_u32 s2, 216
    s_cbranch_scc0 L_skip_81
    s_mul_i32 s56, s7, 10304
    s_mul_i32 s57, s6, 2560
    s_add_u32 s56, s56, s57
    v_lshrrev_b32 v124, 5, v1
    v_lshl_add_u32 v124, v124, 4, v2
    v_lshl_add_u32 v124, v124, 4, s56
    s_mov_b32 exec_lo, 0xffff
    s_mov_b32 exec_hi, 0xffff
    ds_write_b128 v124, v[28:31] offset:0
    ds_write_b128 v124, v[32:35] offset:512
    ds_write_b128 v124, v[36:39] offset:1024
    ds_write_b128 v124, v[40:43] offset:1536
    ds_write_b128 v124, v[44:47] offset:2048
    s_mov_b64 exec, -1
L_skip_81:
L_x_82:
    v_mov_b32 v210, 161792
    v_and_b32 v211, 31, v1
    v_lshlrev_b32 v211, 7, v211
    v_lshlrev_b32 v208, 4, v3
    v_lshrrev_b32 v209, 5, v1
    v_mul_u32_u24 v209, 96, v209
    v_add_u32 v209, v209, v208
    s_lshl_b32 s51, s4, 7
    s_add_u32 s51, s51, 73728
    s_mov_b32 s50, 73728
    s_waitcnt lgkmcnt(0)
    s_barrier
    s_cmp_ge_u32 s2, 216
    s_cbranch_scc0 L_skip_83
    s_mul_i32 s56, s3, 7168
    v_add_u32 v252, s56, v4
    s_cmp_eq_u32 s3, 7
    s_cbranch_scc0 L_skip_84
    v_mov_b32 v48, 0
    v_mov_b32 v49, 0
    v_mov_b32 v50, 0
    v_mov_b32 v51, 0
    v_mov_b32 v52, 0
    v_mov_b32 v53, 0
    v_mov_b32 v54, 0
    v_mov_b32 v55, 0
L_skip_84:
    ds_write_b128 v252, v[28:31] offset:0
    ds_write_b128 v252, v[32:35] offset:1024
    ds_write_b128 v252, v[36:39] offset:2048
    ds_write_b128 v252, v[40:43] offset:3072
    ds_write_b128 v252, v[44:47] offset:4096
    ds_write_b128 v252, v[48:51] offset:5120
    ds_write_b128 v252, v[52:55] offset:6144
    v_bfe_u32 v253, v1, 2, 2
    v_lshl_add_u32 v253, v3, 3, v253
    v_lshlrev_b32 v253, 5, v253
    v_and_b32 v254, 3, v1
    v_lshl_add_u32 v253, v254, 3, v253
    v_add_u32 v253, s56, v253
    s_waitcnt lgkmcnt(0)
    ds_read_b64_tr_b16 v[224:225], v253 offset:0
    ds_read_b64_tr_b16 v[226:227], v253 offset:128
    ds_read_b64_tr_b16 v[228:229], v253 offset:1024
    ds_read_b64_tr_b16 v[230:231], v253 offset:1152
    ds_read_b64_tr_b16 v[232:233], v253 offset:2048
    ds_read_b64_tr_b16 v[234:235], v253 offset:2176
    ds_read_b64_tr_b16 v[236:237], v253 offset:3072
    ds_read_b64_tr_b16 v[238:239], v253 offset:3200
    ds_read_b64_tr_b16 v[240:241], v253 offset:4096
    ds_read_b64_tr_b16 v[242:243], v253 offset:4224
    ds_read_b64_tr_b16 v[244:245], v253 offset:5120
    ds_read_b64_tr_b16 v[246:247], v253 offset:5248
    ds_read_b64_tr_b16 v[248:249], v253 offset:6144
    ds_read_b64_tr_b16 v[250:251], v253 offset:6272
    s_waitcnt lgkmcnt(0)
L_skip_83:
    s_cmp_eq_u32 s3, 0
    s_cbranch_scc0 L_skip_85
    s_cmp_eq_u32 s5, 0
    s_cbranch_scc0 L_skip_86
    ds_read_b128 v[212:215], v210 offset:16
    s_waitcnt lgkmcnt(0)
    v_max_u32 v212, v212, v213
    v_max3_u32 v212, v212, v214, v215
    s_mov_b64 exec, 1
    buffer_store_dword v212, v211, s[32:35], s51 offen sc1
    s_mov_b64 exec, -1
L_skip_86:
    s_cmp_lt_u32 s2, 216
    s_cbranch_scc0 L_skip_87
    v_bfe_u32 v8, v1, 2, 2
    v_lshl_add_u32 v8, v3, 3, v8
    v_lshlrev_b32 v8, 4, v8
    v_and_b32 v9, 1, v1
    v_lshl_add_u32 v8, v9, 3, v8
    v_bfe_u32 v9, v1, 1, 1
    v_mul_u32_u24 v9, 10304, v9
    v_add_u32 v8, v8, v9
    ds_read_b64_tr_b16 v[128:129], v8 offset:0
    ds_read_b64_tr_b16 v[130:131], v8 offset:64
    ds_read_b64_tr_b16 v[132:133], v8 offset:512
    ds_read_b64_tr_b16 v[134:135], v8 offset:576
    ds_read_b64_tr_b16 v[136:137], v8 offset:1024
    ds_read_b64_tr_b16 v[138:139], v8 offset:1088
    ds_read_b64_tr_b16 v[140:141], v8 offset:1536
    ds_read_b64_tr_b16 v[142:143], v8 offset:1600
    ds_read_b64_tr_b16 v[144:145], v8 offset:2048
    ds_read_b64_tr_b16 v[146:147], v8 offset:2112
    ds_read_b64_tr_b16 v[148:149], v8 offset:2560
    ds_read_b64_tr_b16 v[150:151], v8 offset:2624
    s_waitcnt lgkmcnt(2)
    ds_read_b64_tr_b16 v[152:153], v8 offset:3072
    ds_read_b64_tr_b16 v[154:155], v8 offset:3136
    ds_read_b64_tr_b16 v[156:157], v8 offset:3584
    ds_read_b64_tr_b16 v[158:159], v8 offset:3648
    ds_read_b64_tr_b16 v[160:161], v8 offset:4096
    ds_read_b64_tr_b16 v[162:163], v8 offset:4160
    ds_read_b64_tr_b16 v[164:165], v8 offset:4608
    ds_read_b64_tr_b16 v[166:167], v8 offset:4672
    ds_read_b64_tr_b16 v[168:169], v8 offset:5120
    ds_read_b64_tr_b16 v[170:171], v8 offset:5184
    ds_read_b64_tr_b16 v[172:173], v8 offset:5632
    ds_read_b64_tr_b16 v[174:175], v8 offset:5696
    s_waitcnt lgkmcnt(2)
    ds_read_b64_tr_b16 v[176:177], v8 offset:6144
    ds_read_b64_tr_b16 v[178:179], v8 offset:6208
    ds_read_b64_tr_b16 v[180:181], v8 offset:6656
    ds_read_b64_tr_b16 v[182:183], v8 offset:6720
    ds_read_b64_tr_b16 v[184:185], v8 offset:7168
    ds_read_b64_tr_b16 v[186:187], v8 offset:7232
    ds_read_b64_tr_b16 v[188:189], v8 offset:7680
    ds_read_b64_tr_b16 v[190:191], v8 offset:7744
    ds_read_b64_tr_b16 v[192:193], v8 offset:8192
    ds_read_b64_tr_b16 v[194:195], v8 offset:8256
    ds_read_b64_tr_b16 v[196:197], v8 offset:8704
    ds_read_b64_tr_b16 v[198:199], v8 offset:8768
    s_waitcnt lgkmcnt(2)
    ds_read_b64_tr_b16 v[200:201], v8 offset:9216
    ds_read_b64_tr_b16 v[202:203], v8 offset:9280
    ds_read_b64_tr_b16 v[204:205], v8 offset:9728
    ds_read_b64_tr_b16 v[206:207], v8 offset:9792
L_skip_87:
    s_mov_b32 exec_hi, 0
    s_mov_b32 s49, 0
L_spin_88:
    buffer_load_dword v212, v211, s[32:35], s50 offen sc1
    s_waitcnt vmcnt(0)
    v_cmp_eq_u32 vcc, -1, v212
    s_cbranch_vccz L_got_89
    s_add_u32 s49, s49, 1
    s_cmp_lt_u32 s49, 200000
    s_cbranch_scc1 L_spin_88
L_got_89:
    v_max_u32_dpp v212, v212, v212 row_ror:8 row_mask:0xf bank_mask:0xf
    s_nop 1
    v_max_u32_dpp v212, v212, v212 row_ror:4 row_mask:0xf bank_mask:0xf
    s_nop 1
    v_max_u32_dpp v212, v212, v212 row_ror:2 row_mask:0xf bank_mask:0xf
    s_nop 1
    v_max_u32_dpp v212, v212, v212 row_ror:1 row_mask:0xf bank_mask:0xf
    s_nop 1
    v_readlane_b32 s50, v212, 0
    v_readlane_b32 s51, v212, 16
    s_mov_b32 exec_hi, -1
    s_nop 0
    s_max_u32 s93, s50, s51
    v_mov_b32 v213, s93
    ds_write_b32 v210, v213
    s_cmp_lt_u32 s2, 216
    s_cbranch_scc0 L_skip_85
    s_and_b32 s50, s93, 2047
    s_sub_u32 s50, 2047, s50
    s_lshr_b32 s50, s50, 6
    s_lshl_b32 s50, s50, 11
    s_add_u32 s50, s50, 114688
    buffer_load_dwordx4 v[8:11], v208, s[32:35], s50 offen offset:0 sc1
    buffer_load_dwordx4 v[12:15], v208, s[32:35], s50 offen offset:64 sc1
    buffer_load_dwordx4 v[16:19], v209, s[32:35], s50 offen offset:128 sc1
    buffer_load_dwordx4 v[20:23], v208, s[32:35], s50 offen offset:288 sc1
    buffer_load_dwordx4 v[24:27], v208, s[32:35], s50 offen offset:352 sc1
    buffer_load_dwordx4 v[28:31], v208, s[32:35], s50 offen offset:512 sc1
    buffer_load_dwordx4 v[32:35], v208, s[32:35], s50 offen offset:576 sc1
    buffer_load_dwordx4 v[36:39], v209, s[32:35], s50 offen offset:640 sc1
    buffer_load_dwordx4 v[40:43], v208, s[32:35], s50 offen offset:800 sc1
    buffer_load_dwordx4 v[44:47], v208, s[32:35], s50 offen offset:864 sc1
    buffer_load_dwordx4 v[48:51], v208, s[32:35], s50 offen offset:1024 sc1
    buffer_load_dwordx4 v[52:55], v208, s[32:35], s50 offen offset:1088 sc1
    buffer_load_dwordx4 v[56:59], v209, s[32:35], s50 offen offset:1152 sc1
    buffer_load_dwordx4 v[60:63], v208, s[32:35], s50 offen offset:1312 sc1
    buffer_load_dwordx4 v[64:67], v208, s[32:35], s50 offen offset:1376 sc1
    buffer_load_dwordx4 v[68:71], v208, s[32:35], s50 offen offset:1536 sc1
    buffer_load_dwordx4 v[72:75], v208, s[32:35], s50 offen offset:1600 sc1
    buffer_load_dwordx4 v[76:79], v209, s[32:35], s50 offen offset:1664 sc1
    buffer_load_dwordx4 v[80:83], v208, s[32:35], s50 offen offset:1824 sc1
    buffer_load_dwordx4 v[84:87], v208, s[32:35], s50 offen offset:1888 sc1
    s_waitcnt lgkmcnt(0)
    s_barrier
    s_mov_b32 s49, 0
L_f1go:
    s_waitcnt vmcnt(19)
    v_mfma_f32_16x16x32_bf16 v[212:215], v[128:131], v[8:11], 0
    v_max_u32 v210, v8, v9
    v_max3_u32 v210, v210, v10, v11
    s_waitcnt vmcnt(18)
    v_mfma_f32_16x16x32_bf16 v[212:215], v[132:135], v[12:15], v[212:215]
    v_max3_u32 v210, v210, v12, v13
    v_max3_u32 v210, v210, v14, v15
    s_waitcnt vmcnt(17)
    v_mfma_f32_16x16x32_bf16 v[212:215], v[136:139], v[16:19], v[212:215]
    v_max3_u32 v210, v210, v16, v17
    v_max3_u32 v210, v210, v18, v19
    s_waitcnt vmcnt(16)
    v_mfma_f32_16x16x32_bf16 v[212:215], v[140:143], v[20:23], v[212:215]
    v_max3_u32 v210, v210, v20, v21
    v_max3_u32 v210, v210, v22, v23
    s_waitcnt vmcnt(15)
    v_mfma_f32_16x16x32_bf16 v[212:215], v[144:147], v[24:27], v[212:215]
    v_max3_u32 v210, v210, v24, v25
    v_max3_u32 v210, v210, v26, v27
    s_waitcnt vmcnt(14)
    v_mfma_f32_16x16x32_bf16 v[212:215], v[148:151], v[28:31], v[212:215]
    v_max3_u32 v210, v210, v28, v29
    v_max3_u32 v210, v210, v30, v31
    s_waitcnt vmcnt(13)
    v_mfma_f32_16x16x32_bf16 v[212:215], v[152:155], v[32:35], v[212:215]
    v_max3_u32 v210, v210, v32, v33
    v_max3_u32 v210, v210, v34, v35
    s_waitcnt vmcnt(12)
    v_mfma_f32_16x16x32_bf16 v[212:215], v[156:159], v[36:39], v[212:215]
    v_max3_u32 v210, v210, v36, v37
    v_max3_u32 v210, v210, v38, v39
    s_waitcnt vmcnt(11)
    v_mfma_f32_16x16x32_bf16 v[212:215], v[160:163], v[40:43], v[212:215]
    v_max3_u32 v210, v210, v40, v41
    v_max3_u32 v210, v210, v42, v43
    s_waitcnt vmcnt(10)
    v_mfma_f32_16x16x32_bf16 v[212:215], v[164:167], v[44:47], v[212:215]
    v_max3_u32 v210, v210, v44, v45
    v_max3_u32 v210, v210, v46, v47
    s_waitcnt vmcnt(9)
    v_mfma_f32_16x16x32_bf16 v[212:215], v[168:171], v[48:51], v[212:215]
    v_max3_u32 v210, v210, v48, v49
    v_max3_u32 v210, v210, v50, v51
    s_waitcnt vmcnt(8)
    v_mfma_f32_16x16x32_bf16 v[212:215], v[172:175], v[52:55], v[212:215]
    v_max3_u32 v210, v210, v52, v53
    v_max3_u32 v210, v210, v54, v55
    s_waitcnt vmcnt(7)
    v_mfma_f32_16x16x32_bf16 v[212:215], v[176:179], v[56:59], v[212:215]
    v_max3_u32 v210, v210, v56, v57
    v_max3_u32 v210, v210, v58, v59
    s_waitcnt vmcnt(6)
    v_mfma_f32_16x16x32_bf16 v[212:215], v[180:183], v[60:63], v[212:215]
    v_max3_u32 v210, v210, v60, v61
    v_max3_u32 v210, v210, v62, v63
    s_waitcnt vmcnt(5)
    v_mfma_f32_16x16x32_bf16 v[212:215], v[184:187], v[64:67], v[212:215]
    v_max3_u32 v210, v210, v64, v65
    v_max3_u32 v210, v210, v66, v67
    s_waitcnt vmcnt(4)
    v_mfma_f32_16x16x32_bf16 v[212:215], v[188:191], v[68:71], v[212:215]
    v_max3_u32 v210, v210, v68, v69
    v_max3_u32 v210, v210, v70, v71
    s_waitcnt vmcnt(3)
    v_mfma_f32_16x16x32_bf16 v[212:215], v[192:195], v[72:75], v[212:215]
    v_max3_u32 v210, v210, v72, v73
    v_max3_u32 v210, v210, v74, v75
    s_waitcnt vmcnt(2)
    v_mfma_f32_16x16x32_bf16 v[212:215], v[196:199], v[76:79], v[212:215]
    v_max3_u32 v210, v210, v76, v77
    v_max3_u32 v210, v210, v78, v79
    s_waitcnt vmcnt(1)
    v_mfma_f32_16x16x32_bf16 v[212:215], v[200:203], v[80:83], v[212:215]
    v_max3_u32 v210, v210, v80, v81
    v_max3_u32 v210, v210, v82, v83
    s_waitcnt vmcnt(0)
    v_mfma_f32_16x16x32_bf16 v[212:215], v[204:207], v[84:87], v[212:215]
    v_max3_u32 v210, v210, v84, v85
    v_max3_u32 v210, v210, v86, v87
    v_cmp_eq_u32 vcc, -1, v210
    s_cbranch_vccnz L_f1retry
L_f1ok:
    s_nop 4
    v_mov_b32 v216, v212
    v_mov_b32 v217, v213
    v_mov_b32 v218, v214
    v_mov_b32 v219, v215
    s_nop 1
    v_permlane32_swap_b32 v212, v216
    v_permlane32_swap_b32 v213, v217
    v_permlane32_swap_b32 v214, v218
    v_permlane32_swap_b32 v215, v219
    v_mul_f32 v220, 0xbfb8aa3b, v212
    v_mul_f32 v221, 0xbfb8aa3b, v213
    v_mul_f32 v222, 0xbfb8aa3b, v214
    v_mul_f32 v223, 0xbfb8aa3b, v215
    v_exp_f32 v220, v220
    v_exp_f32 v221, v221
    v_exp_f32 v222, v222
    v_exp_f32 v223, v223
    v_add_f32 v220, 1.0, v220
    v_add_f32 v221, 1.0, v221
    v_add_f32 v222, 1.0, v222
    v_add_f32 v223, 1.0, v223
    v_rcp_f32 v220, v220
    v_rcp_f32 v221, v221
    v_rcp_f32 v222, v222
    v_rcp_f32 v223, v223
    v_mul_f32 v212, v212, v216
    v_mul_f32 v213, v213, v217
    v_mul_f32 v214, v214, v218
    v_mul_f32 v215, v215, v219
    v_mul_f32 v212, v212, v220
    v_mul_f32 v213, v213, v221
    v_mul_f32 v214, v214, v222
    v_mul_f32 v215, v215, v223
    v_cvt_pk_bf16_f32 v216, v212, v213
    v_cvt_pk_bf16_f32 v217, v214, v215
    s_mul_i32 s50, s78, 128
    s_add_u32 s50, s50, 77824
    v_lshlrev_b32 v208, 3, v3
    s_mov_b64 exec, 0x10001
    buffer_store_dwordx2 v[216:217], v208, s[32:35], s50 offen sc1
    s_mov_b64 exec, -1
    s_barrier
    s_branch L_fin
L_skip_85:
    s_waitcnt lgkmcnt(0)
    s_barrier
L_tail_73:
    s_cmp_ge_u32 s2, 216
    s_cbranch_scc0 L_fin
    s_cmp_eq_u32 s3, 7
    s_cselect_b32 s51, 4, 6
    v_min_u32 v66, s51, v2
    v_lshl_add_u32 v66, v66, 2, v3
    v_mul_u32_u24 v66, 128, v66
    v_lshlrev_b32 v67, 2, v2
    s_mul_i32 s50, s3, 3584
    s_add_u32 s50, s50, 77824
    s_and_b32 s52, s2, 7
    s_lshl_b32 s52, s52, 10
    s_lshr_b32 s53, s2, 3
    s_sub_u32 s53, s53, 27
    s_lshl_b32 s53, s53, 6
    s_add_u32 s52, s52, s53
    s_add_u32 s52, s52, 106496
    v_mov_b32 v68, 0
    v_mov_b32 v69, 0
    v_mov_b32 v76, 0
    v_mov_b32 v77, 0
    v_mov_b32 v78, 0
    v_mov_b32 v79, 0
    s_mov_b32 s49, 0
L_spin_90:
    s_mov_b32 exec_lo, 0x007f007f
    s_mov_b32 exec_hi, 0x007f007f
    buffer_load_dwordx4 v[76:79], v66, s[32:35], s50 offen sc1
    s_mov_b64 exec, -1
    s_cmp_eq_u32 s3, 0
    s_cbranch_scc0 L_skip_91
    buffer_load_dword v68, v67, s[32:35], s52 offen sc1
    buffer_load_dword v69, v67, s[32:35], s52 offen offset:512 sc1
L_skip_91:
    s_waitcnt vmcnt(0)
    v_max_u32 v70, v76, v77
    v_max3_u32 v70, v70, v78, v79
    v_max3_u32 v70, v70, v68, v69
    v_cmp_eq_u32 vcc, -1, v70
    s_cbranch_vccz L_got_92
    s_add_u32 s49, s49, 1
    s_cmp_lt_u32 s49, 200000
    s_cbranch_scc1 L_spin_90
L_got_92:
    v_mov_b32_dpp v128, v76 row_newbcast:0 row_mask:0xf bank_mask:0xf
    v_mov_b32_dpp v129, v77 row_newbcast:0 row_mask:0xf bank_mask:0xf
    v_mov_b32_dpp v130, v78 row_newbcast:0 row_mask:0xf bank_mask:0xf
    v_mov_b32_dpp v131, v79 row_newbcast:0 row_mask:0xf bank_mask:0xf
    v_mov_b32_dpp v132, v76 row_newbcast:1 row_mask:0xf bank_mask:0xf
    v_mov_b32_dpp v133, v77 row_newbcast:1 row_mask:0xf bank_mask:0xf
    v_mov_b32_dpp v134, v78 row_newbcast:1 row_mask:0xf bank_mask:0xf
    v_mov_b32_dpp v135, v79 row_newbcast:1 row_mask:0xf bank_mask:0xf
    v_mfma_f32_16x16x32_bf16 v[72:75], v[224:227], v[128:131], 0
    v_mov_b32_dpp v136, v76 row_newbcast:2 row_mask:0xf bank_mask:0xf
    v_mov_b32_dpp v137, v77 row_newbcast:2 row_mask:0xf bank_mask:0xf
    v_mov_b32_dpp v138, v78 row_newbcast:2 row_mask:0xf bank_mask:0xf
    v_mov_b32_dpp v139, v79 row_newbcast:2 row_mask:0xf bank_mask:0xf
    v_mfma_f32_16x16x32_bf16 v[72:75], v[228:231], v[132:135], v[72:75]
    v_mov_b32_dpp v140, v76 row_newbcast:3 row_mask:0xf bank_mask:0xf
    v_mov_b32_dpp v141, v77 row_newbcast:3 row_mask:0xf bank_mask:0xf
    v_mov_b32_dpp v142, v78 row_newbcast:3 row_mask:0xf bank_mask:0xf
    v_mov_b32_dpp v143, v79 row_newbcast:3 row_mask:0xf bank_mask:0xf
    v_mfma_f32_16x16x32_bf16 v[72:75], v[232:235], v[136:139], v[72:75]
    v_mov_b32_dpp v144, v76 row_newbcast:4 row_mask:0xf bank_mask:0xf
    v_mov_b32_dpp v145, v77 row_newbcast:4 row_mask:0xf bank_mask:0xf
    v_mov_b32_dpp v146, v78 row_newbcast:4 row_mask:0xf bank_mask:0xf
    v_mov_b32_dpp v147, v79 row_newbcast:4 row_mask:0xf bank_mask:0xf
    v_mfma_f32_16x16x32_bf16 v[72:75], v[236:239], v[140:143], v[72:75]
    v_mov_b32_dpp v148, v76 row_newbcast:5 row_mask:0xf bank_mask:0xf
    v_mov_b32_dpp v149, v77 row_newbcast:5 row_mask:0xf bank_mask:0xf
    v_mov_b32_dpp v150, v78 row_newbcast:5 row_mask:0xf bank_mask:0xf
    v_mov_b32_dpp v151, v79 row_newbcast:5 row_mask:0xf bank_mask:0xf
    v_mfma_f32_16x16x32_bf16 v[72:75], v[240:243], v[144:147], v[72:75]
    v_mov_b32_dpp v152, v76 row_newbcast:6 row_mask:0xf bank_mask:0xf
    v_mov_b32_dpp v153, v77 row_newbcast:6 row_mask:0xf bank_mask:0xf
    v_mov_b32_dpp v154, v78 row_newbcast:6 row_mask:0xf bank_mask:0xf
    v_mov_b32_dpp v155, v79 row_newbcast:6 row_mask:0xf bank_mask:0xf
    v_mfma_f32_16x16x32_bf16 v[72:75], v[244:247], v[148:151], v[72:75]
    s_nop 1
    v_mfma_f32_16x16x32_bf16 v[72:75], v[248:251], v[152:155], v[72:75]
    s_lshl_b32 s50, s3, 6
    s_add_u32 s50, s50, 161920
    v_lshl_add_u32 v64, v3, 4, s50
    s_mov_b32 exec_lo, 0x10001
    s_mov_b32 exec_hi, 0x10001
    s_nop 3
    ds_write_b128 v64, v[72:75]
    s_mov_b64 exec, -1
    s_cmp_eq_u32 s3, 0
    s_cbranch_scc0 L_skip_93
    s_and_b32 s52, s93, 0xfffff800
    s_not_b32 s53, s52
    s_xor_b32 s54, s52, 0x80000000
    s_cmp_lt_i32 s52, 0
    s_cselect_b32 s52, s54, s53
    v_mov_b32 v70, 0xbfb8aa3b
    v_mul_f32 v70, s52, v70
    v_exp_f32 v70, v70
    s_and_b32 s50, s93, 2047
    v_add_f32 v70, 1.0, v70
    v_rcp_f32 v70, v70
    s_sub_u32 s50, 2047, s50
    v_mul_f32 v69, v69, v70
    s_mul_i32 s50, s50, 1280
    s_lshl_b32 s51, s78, 5
    s_add_u32 s50, s50, s51
    v_add_u32 v65, 161920, v67
    v_lshlrev_b32 v66, 1, v2
L_skip_93:
    s_waitcnt lgkmcnt(0)
    s_barrier
    s_cmp_eq_u32 s3, 0
    s_cbranch_scc0 L_fin
    ds_read_b32 v76, v65 offset:0
    ds_read_b32 v77, v65 offset:64
    ds_read_b32 v78, v65 offset:128
    ds_read_b32 v79, v65 offset:192
    ds_read_b32 v80, v65 offset:256
    ds_read_b32 v81, v65 offset:320
    ds_read_b32 v82, v65 offset:384
    ds_read_b32 v83, v65 offset:448
    s_waitcnt lgkmcnt(0)
    v_add_f32 v76, v76, v77
    v_add_f32 v78, v78, v79
    v_add_f32 v80, v80, v81
    v_add_f32 v82, v82, v83
    v_add_f32 v76, v76, v78
    v_add_f32 v80, v80, v82
    v_add_f32 v76, v76, v80
    v_fma_f32 v68, v76, v69, v68
    v_cvt_pk_bf16_f32 v68, v68, v68
    s_mov_b64 exec, 0xffff
    buffer_store_short v68, v66, s[36:39], s50 offen
    s_mov_b64 exec, -1
L_fin:
    s_endpgm
L_oretry_45:
    s_mov_b32 s49, 0
L_spin_94:
    buffer_load_dwordx4 v[64:67], v61, s[32:35], s60 offen sc1
    s_waitcnt vmcnt(0)
    v_max_u32 v63, v64, v65
    v_max3_u32 v63, v63, v66, v67
    v_cmp_eq_u32 vcc, -1, v63
    s_cbranch_vccz L_got_95
    s_add_u32 s49, s49, 1
    s_cmp_lt_u32 s49, 200000
    s_cbranch_scc1 L_spin_94
L_got_95:
    buffer_load_dwordx4 v[68:71], v61, s[32:35], s61 offen sc1
    buffer_load_dwordx4 v[72:75], v61, s[32:35], s62 offen sc1
    s_branch L_oback_46
L_oretry_47:
    s_mov_b32 s49, 0
L_spin_96:
    buffer_load_dwordx4 v[68:71], v61, s[32:35], s61 offen sc1
    s_waitcnt vmcnt(0)
    v_max_u32 v63, v68, v69
    v_max3_u32 v63, v63, v70, v71
    v_cmp_eq_u32 vcc, -1, v63
    s_cbranch_vccz L_got_97
    s_add_u32 s49, s49, 1
    s_cmp_lt_u32 s49, 200000
    s_cbranch_scc1 L_spin_96
L_got_97:
    buffer_load_dwordx4 v[72:75], v61, s[32:35], s62 offen sc1
    buffer_load_dwordx4 v[76:79], v61, s[32:35], s63 offen sc1
    s_branch L_oback_48
L_oretry_49:
    s_mov_b32 s49, 0
L_spin_98:
    buffer_load_dwordx4 v[72:75], v61, s[32:35], s62 offen sc1
    s_waitcnt vmcnt(0)
    v_max_u32 v63, v72, v73
    v_max3_u32 v63, v63, v74, v75
    v_cmp_eq_u32 vcc, -1, v63
    s_cbranch_vccz L_got_99
    s_add_u32 s49, s49, 1
    s_cmp_lt_u32 s49, 200000
    s_cbranch_scc1 L_spin_98
L_got_99:
    buffer_load_dwordx4 v[76:79], v61, s[32:35], s63 offen sc1
    buffer_load_dwordx4 v[80:83], v61, s[32:35], s64 offen sc1
    s_branch L_oback_50
L_oretry_51:
    s_mov_b32 s49, 0
L_spin_100:
    buffer_load_dwordx4 v[76:79], v61, s[32:35], s63 offen sc1
    s_waitcnt vmcnt(0)
    v_max_u32 v63, v76, v77
    v_max3_u32 v63, v63, v78, v79
    v_cmp_eq_u32 vcc, -1, v63
    s_cbranch_vccz L_got_101
    s_add_u32 s49, s49, 1
    s_cmp_lt_u32 s49, 200000
    s_cbranch_scc1 L_spin_100
L_got_101:
    buffer_load_dwordx4 v[80:83], v61, s[32:35], s64 offen sc1
    buffer_load_dwordx4 v[84:87], v61, s[32:35], s65 offen sc1
    s_branch L_oback_52
L_oretry_53:
    s_mov_b32 s49, 0
L_spin_102:
    buffer_load_dwordx4 v[80:83], v61, s[32:35], s64 offen sc1
    s_waitcnt vmcnt(0)
    v_max_u32 v63, v80, v81
    v_max3_u32 v63, v63, v82, v83
    v_cmp_eq_u32 vcc, -1, v63
    s_cbranch_vccz L_got_103
    s_add_u32 s49, s49, 1
    s_cmp_lt_u32 s49, 200000
    s_cbranch_scc1 L_spin_102
L_got_103:
    buffer_load_dwordx4 v[84:87], v61, s[32:35], s65 offen sc1
    buffer_load_dwordx4 v[88:91], v61, s[32:35], s66 offen sc1
    s_branch L_oback_54
L_oretry_55:
    s_mov_b32 s49, 0
L_spin_104:
    buffer_load_dwordx4 v[84:87], v61, s[32:35], s65 offen sc1
    s_waitcnt vmcnt(0)
    v_max_u32 v63, v84, v85
    v_max3_u32 v63, v63, v86, v87
    v_cmp_eq_u32 vcc, -1, v63
    s_cbranch_vccz L_got_105
    s_add_u32 s49, s49, 1
    s_cmp_lt_u32 s49, 200000
    s_cbranch_scc1 L_spin_104
L_got_105:
    buffer_load_dwordx4 v[88:91], v61, s[32:35], s66 offen sc1
    buffer_load_dwordx4 v[92:95], v61, s[32:35], s67 offen sc1
    s_branch L_oback_56
L_oretry_57:
    s_mov_b32 s49, 0
L_spin_106:
    buffer_load_dwordx4 v[88:91], v61, s[32:35], s66 offen sc1
    s_waitcnt vmcnt(0)
    v_max_u32 v63, v88, v89
    v_max3_u32 v63, v63, v90, v91
    v_cmp_eq_u32 vcc, -1, v63
    s_cbranch_vccz L_got_107
    s_add_u32 s49, s49, 1
    s_cmp_lt_u32 s49, 200000
    s_cbranch_scc1 L_spin_106
L_got_107:
    buffer_load_dwordx4 v[92:95], v61, s[32:35], s67 offen sc1
    buffer_load_dwordx4 v[96:99], v61, s[32:35], s68 offen sc1
    s_branch L_oback_58
L_oretry_60:
    s_mov_b32 s49, 0
L_spin_108:
    buffer_load_dwordx4 v[92:95], v61, s[32:35], s67 offen sc1
    s_waitcnt vmcnt(0)
    v_max_u32 v63, v92, v93
    v_max3_u32 v63, v63, v94, v95
    v_cmp_eq_u32 vcc, -1, v63
    s_cbranch_vccz L_got_109
    s_add_u32 s49, s49, 1
    s_cmp_lt_u32 s49, 200000
    s_cbranch_scc1 L_spin_108
L_got_109:
    buffer_load_dwordx4 v[96:99], v61, s[32:35], s68 offen sc1
    buffer_load_dwordx4 v[100:103], v61, s[32:35], s69 offen sc1
    s_branch L_oback_61
L_oretry_62:
    s_mov_b32 s49, 0
L_spin_110:
    buffer_load_dwordx4 v[96:99], v61, s[32:35], s68 offen sc1
    s_waitcnt vmcnt(0)
    v_max_u32 v63, v96, v97
    v_max3_u32 v63, v63, v98, v99
    v_cmp_eq_u32 vcc, -1, v63
    s_cbranch_vccz L_got_111
    s_add_u32 s49, s49, 1
    s_cmp_lt_u32 s49, 200000
    s_cbranch_scc1 L_spin_110
L_got_111:
    buffer_load_dwordx4 v[100:103], v61, s[32:35], s69 offen sc1
    s_branch L_oback_63
L_oretry_64:
    s_mov_b32 s49, 0
L_spin_112:
    buffer_load_dwordx4 v[100:103], v61, s[32:35], s69 offen sc1
    s_waitcnt vmcnt(0)
    v_max_u32 v63, v100, v101
    v_max3_u32 v63, v63, v102, v103
    v_cmp_eq_u32 vcc, -1, v63
    s_cbranch_vccz L_got_113
    s_add_u32 s49, s49, 1
    s_cmp_lt_u32 s49, 200000
    s_cbranch_scc1 L_spin_112
L_got_113:
    s_branch L_oback_65
L_oretry_75:
    s_mov_b32 s49, 0
L_spin_114:
    buffer_load_dwordx4 v[92:95], v61, s[32:35], s67 offen sc1
    s_waitcnt vmcnt(0)
    v_max_u32 v63, v92, v93
    v_max3_u32 v63, v63, v94, v95
    v_cmp_eq_u32 vcc, -1, v63
    s_cbranch_vccz L_got_115
    s_add_u32 s49, s49, 1
    s_cmp_lt_u32 s49, 200000
    s_cbranch_scc1 L_spin_114
L_got_115:
    buffer_load_dwordx4 v[96:99], v61, s[32:35], s68 offen sc1
    buffer_load_dwordx4 v[100:103], v61, s[32:35], s69 offen sc1
    s_branch L_oback_76
L_oretry_77:
    s_mov_b32 s49, 0
L_spin_116:
    buffer_load_dwordx4 v[96:99], v61, s[32:35], s68 offen sc1
    s_waitcnt vmcnt(0)
    v_max_u32 v63, v96, v97
    v_max3_u32 v63, v63, v98, v99
    v_cmp_eq_u32 vcc, -1, v63
    s_cbranch_vccz L_got_117
    s_add_u32 s49, s49, 1
    s_cmp_lt_u32 s49, 200000
    s_cbranch_scc1 L_spin_116
L_got_117:
    buffer_load_dwordx4 v[100:103], v61, s[32:35], s69 offen sc1
    s_branch L_oback_78
L_oretry_79:
    s_mov_b32 s49, 0
L_spin_118:
    buffer_load_dwordx4 v[100:103], v61, s[32:35], s69 offen sc1
    s_waitcnt vmcnt(0)
    v_max_u32 v63, v100, v101
    v_max3_u32 v63, v63, v102, v103
    v_cmp_eq_u32 vcc, -1, v63
    s_cbranch_vccz L_got_119
    s_add_u32 s49, s49, 1
    s_cmp_lt_u32 s49, 200000
    s_cbranch_scc1 L_spin_118
L_got_119:
    s_branch L_oback_80
L_ltretry:
    s_mov_b32 s49, 0
L_spin_120:
    s_sleep 8
    ds_read_b32 v51, v50
    ds_read_b128 v[34:37], v33 offset:0
    ds_read_b128 v[38:41], v33 offset:1024
    ds_read_b128 v[42:45], v33 offset:2048
    ds_read_b128 v[46:49], v33 offset:3072
    s_waitcnt lgkmcnt(0)
    v_cmp_eq_u32 vcc, 0, v51
    s_cbranch_vccz L_got_121
    s_add_u32 s49, s49, 1
    s_cmp_lt_u32 s49, 200000
    s_cbranch_scc1 L_spin_120
L_got_121:
    s_branch L_ltok
L_hretry:
    s_mov_b32 s49, 0
L_spin_122:
    s_add_u32 s50, s53, 0
    buffer_load_dwordx4 v[64:67], v61, s[32:35], s50 offen sc1
    s_add_u32 s50, s53, 16384
    buffer_load_dwordx4 v[68:71], v61, s[32:35], s50 offen sc1
    s_add_u32 s50, s53, 32768
    buffer_load_dwordx4 v[72:75], v61, s[32:35], s50 offen sc1
    s_add_u32 s50, s53, 49152
    buffer_load_dwordx4 v[76:79], v61, s[32:35], s50 offen sc1
    s_add_u32 s50, s53, 65536
    buffer_load_dwordx4 v[80:83], v61, s[32:35], s50 offen sc1
    s_add_u32 s50, s58, 0
    buffer_load_dwordx4 v[84:87], v61, s[32:35], s50 offen sc1
    s_add_u32 s50, s58, 16384
    buffer_load_dwordx4 v[88:91], v61, s[32:35], s50 offen sc1
    s_add_u32 s50, s58, 32768
    buffer_load_dwordx4 v[92:95], v61, s[32:35], s50 offen sc1
    s_add_u32 s50, s58, 49152
    buffer_load_dwordx4 v[96:99], v61, s[32:35], s50 offen sc1
    s_add_u32 s50, s58, 65536
    buffer_load_dwordx4 v[100:103], v61, s[32:35], s50 offen sc1
    buffer_load_dword v124, v50, s[32:35], s59 offen offset:0 sc1
    buffer_load_dword v125, v50, s[32:35], s59 offen offset:1024 sc1
    s_waitcnt vmcnt(0)
    v_add3_u32 v126, v64, v65, s57
    v_add3_u32 v126, v126, v66, v67
    v_add3_u32 v126, v68, v69, v126
    v_add3_u32 v126, v126, v70, v71
    v_add3_u32 v126, v72, v73, v126
    v_add3_u32 v126, v126, v74, v75
    v_add3_u32 v126, v76, v77, v126
    v_add3_u32 v126, v126, v78, v79
    v_add3_u32 v126, v80, v81, v126
    v_add3_u32 v126, v126, v82, v83
    v_add3_u32 v126, v84, v85, v126
    v_add3_u32 v126, v126, v86, v87
    v_add3_u32 v126, v88, v89, v126
    v_add3_u32 v126, v126, v90, v91
    v_add3_u32 v126, v92, v93, v126
    v_add3_u32 v126, v126, v94, v95
    v_add3_u32 v126, v96, v97, v126
    v_add3_u32 v126, v126, v98, v99
    v_add3_u32 v126, v100, v101, v126
    v_add3_u32 v126, v126, v102, v103
    v_add_u32 v124, v124, v125
    v_cmp_ne_u32 vcc, v126, v124
    s_cbranch_vccz L_got_123
    s_add_u32 s49, s49, 1
    s_cmp_lt_u32 s49, 200000
    s_cbranch_scc1 L_spin_122
L_got_123:
    s_waitcnt lgkmcnt(0)
    v_mfma_f32_16x16x32_bf16 v[104:107], v[128:131], v[64:67], 0
    v_mfma_f32_16x16x32_bf16 v[108:111], v[132:135], v[64:67], 0
    v_mfma_f32_16x16x32_bf16 v[112:115], v[136:139], v[64:67], 0
    v_mfma_f32_16x16x32_bf16 v[116:119], v[140:143], v[64:67], 0
    v_mfma_f32_16x16x32_bf16 v[120:123], v[144:147], v[64:67], 0
    v_mfma_f32_16x16x32_bf16 v[104:107], v[148:151], v[68:71], v[104:107]
    v_mfma_f32_16x16x32_bf16 v[108:111], v[152:155], v[68:71], v[108:111]
    v_mfma_f32_16x16x32_bf16 v[112:115], v[156:159], v[68:71], v[112:115]
    v_mfma_f32_16x16x32_bf16 v[116:119], v[160:163], v[68:71], v[116:119]
    v_mfma_f32_16x16x32_bf16 v[120:123], v[164:167], v[68:71], v[120:123]
    v_mfma_f32_16x16x32_bf16 v[104:107], v[176:179], v[72:75], v[104:107]
    v_mfma_f32_16x16x32_bf16 v[108:111], v[180:183], v[72:75], v[108:111]
    v_mfma_f32_16x16x32_bf16 v[112:115], v[184:187], v[72:75], v[112:115]
    v_mfma_f32_16x16x32_bf16 v[116:119], v[188:191], v[72:75], v[116:119]
    v_mfma_f32_16x16x32_bf16 v[120:123], v[192:195], v[72:75], v[120:123]
    v_mfma_f32_16x16x32_bf16 v[104:107], v[196:199], v[76:79], v[104:107]
    v_mfma_f32_16x16x32_bf16 v[108:111], v[200:203], v[76:79], v[108:111]
    v_mfma_f32_16x16x32_bf16 v[112:115], v[204:207], v[76:79], v[112:115]
    v_mfma_f32_16x16x32_bf16 v[116:119], v[208:211], v[76:79], v[116:119]
    v_mfma_f32_16x16x32_bf16 v[120:123], v[212:215], v[76:79], v[120:123]
    v_mfma_f32_16x16x32_bf16 v[104:107], v[216:219], v[80:83], v[104:107]
    v_mfma_f32_16x16x32_bf16 v[108:111], v[220:223], v[80:83], v[108:111]
    v_mfma_f32_16x16x32_bf16 v[112:115], v[224:227], v[80:83], v[112:115]
    v_mfma_f32_16x16x32_bf16 v[116:119], v[228:231], v[80:83], v[116:119]
    v_mfma_f32_16x16x32_bf16 v[120:123], v[232:235], v[80:83], v[120:123]
    v_mfma_f32_16x16x32_bf16 v[8:11], v[128:131], v[84:87], 0
    v_mfma_f32_16x16x32_bf16 v[12:15], v[132:135], v[84:87], 0
    v_mfma_f32_16x16x32_bf16 v[16:19], v[136:139], v[84:87], 0
    v_mfma_f32_16x16x32_bf16 v[20:23], v[140:143], v[84:87], 0
    v_mfma_f32_16x16x32_bf16 v[24:27], v[144:147], v[84:87], 0
    v_mfma_f32_16x16x32_bf16 v[8:11], v[148:151], v[88:91], v[8:11]
    v_mfma_f32_16x16x32_bf16 v[12:15], v[152:155], v[88:91], v[12:15]
    v_mfma_f32_16x16x32_bf16 v[16:19], v[156:159], v[88:91], v[16:19]
    v_mfma_f32_16x16x32_bf16 v[20:23], v[160:163], v[88:91], v[20:23]
    v_mfma_f32_16x16x32_bf16 v[24:27], v[164:167], v[88:91], v[24:27]
    ds_write_b128 v127, v[104:107] offset:0
    ds_write_b128 v127, v[108:111] offset:1024
    ds_write_b128 v127, v[112:115] offset:2048
    ds_write_b128 v127, v[116:119] offset:3072
    ds_write_b128 v127, v[120:123] offset:4096
    s_branch L_hback
L_h1retry:
    s_mov_b32 s49, 0
L_spin_124:
    s_sleep 2
    buffer_load_dwordx4 v[8:11], v120, s[32:35], s54 offen sc1
    buffer_load_dwordx4 v[12:15], v120, s[32:35], s55 offen sc1
    buffer_load_dwordx4 v[16:19], v120, s[32:35], s56 offen sc1
    buffer_load_dwordx4 v[20:23], v120, s[32:35], s57 offen sc1
    s_waitcnt vmcnt(0)
    v_xor_b32 v8, s86, v8
    v_xor_b32 v9, s87, v9
    v_xor_b32 v10, s88, v10
    v_xor_b32 v11, s89, v11
    v_xor_b32 v12, s86, v12
    v_xor_b32 v13, s87, v13
    v_xor_b32 v14, s88, v14
    v_xor_b32 v15, s89, v15
    v_xor_b32 v16, s86, v16
    v_xor_b32 v17, s87, v17
    v_xor_b32 v18, s88, v18
    v_xor_b32 v19, s89, v19
    v_xor_b32 v20, s86, v20
    v_xor_b32 v21, s87, v21
    v_xor_b32 v22, s88, v22
    v_xor_b32 v23, s89, v23
    v_or_b32 v27, v8, v9
    v_or3_b32 v27, v27, v10, v11
    v_or3_b32 v27, v27, v12, v13
    v_or3_b32 v27, v27, v14, v15
    v_or3_b32 v27, v27, v16, v17
    v_or3_b32 v27, v27, v18, v19
    v_or3_b32 v27, v27, v20, v21
    v_or3_b32 v27, v27, v22, v23
    v_and_b32 v27, 0xff, v27
    v_cmp_ne_u32 vcc, 0, v27
    s_cbranch_vccz L_got_125
    s_add_u32 s49, s49, 1
    s_cmp_lt_u32 s49, 200000
    s_cbranch_scc1 L_spin_124
L_got_125:
    s_branch L_h1ok
L_h2retry:
    s_mov_b32 s49, 0
L_spin_126:
    s_mov_b32 s50, 491520
    buffer_load_dword v240, v244, s[32:35], s50 offen sc1
    s_mov_b32 s50, 493568
    buffer_load_dword v241, v244, s[32:35], s50 offen sc1
    s_mov_b32 s50, 495616
    buffer_load_dword v242, v244, s[32:35], s50 offen sc1
    s_mov_b32 s50, 497664
    buffer_load_dword v243, v244, s[32:35], s50 offen sc1
    s_waitcnt vmcnt(0)
    v_xor_b32 v240, s48, v240
    v_xor_b32 v241, s48, v241
    v_xor_b32 v242, s48, v242
    v_xor_b32 v243, s48, v243
    v_or3_b32 v240, v240, v241, v242
    v_or_b32 v240, v240, v243
    v_cmp_ne_u32 vcc, 0, v240
    s_cbranch_vccz L_got_127
    s_add_u32 s49, s49, 1
    s_cmp_lt_u32 s49, 200000
    s_cbranch_scc1 L_spin_126
L_got_127:
    s_branch L_h2ok
L_stretry:
    s_mov_b32 s49, 0
L_spin_128:
    buffer_load_dwordx4 v[72:75], v61, s[32:35], s50 offen sc1
    buffer_load_dwordx4 v[76:79], v61, s[32:35], s52 offen sc1
    s_waitcnt vmcnt(0)
    v_max_u32 v64, v72, v73
    v_max3_u32 v64, v64, v74, v75
    v_max3_u32 v64, v64, v76, v77
    v_max3_u32 v64, v64, v78, v79
    v_cmp_eq_u32 vcc, -1, v64
    s_cbranch_vccz L_got_129
    s_add_u32 s49, s49, 1
    s_cmp_lt_u32 s49, 200000
    s_cbranch_scc1 L_spin_128
L_got_129:
    s_branch L_stok
L_pfretry:
    s_mov_b32 s49, 0
L_spin_130:
    buffer_load_dword v188, v189, s[32:35], s58 offen sc1
    s_waitcnt vmcnt(0)
    v_cmp_ne_u32 s[52:53], s91, v188
    v_xor_b32 v191, s48, v188
    v_cmp_lt_u32 vcc, 15, v191
    s_cbranch_vccz L_got_131
    s_add_u32 s49, s49, 1
    s_cmp_lt_u32 s49, 200000
    s_cbranch_scc1 L_spin_130
L_got_131:
    s_branch L_pfok
L_pmretry:
    s_mov_b32 s49, 0
L_spin_132:
    buffer_load_dwordx4 v[176:179], v186, s[32:35], s54 offen sc1
    buffer_load_dwordx4 v[180:183], v186, s[32:35], s55 offen sc1
    s_waitcnt vmcnt(0)
    v_xor_b32 v176, s86, v176
    v_xor_b32 v177, s87, v177
    v_xor_b32 v178, s88, v178
    v_xor_b32 v179, s89, v179
    v_xor_b32 v180, s86, v180
    v_xor_b32 v181, s87, v181
    v_xor_b32 v182, s88, v182
    v_xor_b32 v183, s89, v183
    v_or_b32 v8, v176, v177
    v_or3_b32 v8, v8, v178, v179
    v_or3_b32 v8, v8, v180, v181
    v_or3_b32 v8, v8, v182, v183
    v_and_b32 v8, 0xff, v8
    v_cmp_ne_u32 vcc, 0, v8
    s_cbranch_vccz L_got_133
    s_add_u32 s49, s49, 1
    s_cmp_lt_u32 s49, 200000
    s_cbranch_scc1 L_spin_132
L_got_133:
    s_branch L_pmok
L_f1retry:
    s_add_u32 s49, s49, 1
    s_cmp_lt_u32 s49, 200000
    s_cbranch_scc0 L_f1ok
    buffer_load_dwordx4 v[8:11], v208, s[32:35], s50 offen offset:0 sc1
    buffer_load_dwordx4 v[12:15], v208, s[32:35], s50 offen offset:64 sc1
    buffer_load_dwordx4 v[16:19], v209, s[32:35], s50 offen offset:128 sc1
    buffer_load_dwordx4 v[20:23], v208, s[32:35], s50 offen offset:288 sc1
    buffer_load_dwordx4 v[24:27], v208, s[32:35], s50 offen offset:352 sc1
    buffer_load_dwordx4 v[28:31], v208, s[32:35], s50 offen offset:512 sc1
    buffer_load_dwordx4 v[32:35], v208, s[32:35], s50 offen offset:576 sc1
    buffer_load_dwordx4 v[36:39], v209, s[32:35], s50 offen offset:640 sc1
    buffer_load_dwordx4 v[40:43], v208, s[32:35], s50 offen offset:800 sc1
    buffer_load_dwordx4 v[44:47], v208, s[32:35], s50 offen offset:864 sc1
    buffer_load_dwordx4 v[48:51], v208, s[32:35], s50 offen offset:1024 sc1
    buffer_load_dwordx4 v[52:55], v208, s[32:35], s50 offen offset:1088 sc1
    buffer_load_dwordx4 v[56:59], v209, s[32:35], s50 offen offset:1152 sc1
    buffer_load_dwordx4 v[60:63], v208, s[32:35], s50 offen offset:1312 sc1
    buffer_load_dwordx4 v[64:67], v208, s[32:35], s50 offen offset:1376 sc1
    buffer_load_dwordx4 v[68:71], v208, s[32:35], s50 offen offset:1536 sc1
    buffer_load_dwordx4 v[72:75], v208, s[32:35], s50 offen offset:1600 sc1
    buffer_load_dwordx4 v[76:79], v209, s[32:35], s50 offen offset:1664 sc1
    buffer_load_dwordx4 v[80:83], v208, s[32:35], s50 offen offset:1824 sc1
    buffer_load_dwordx4 v[84:87], v208, s[32:35], s50 offen offset:1888 sc1
    s_branch L_f1go
L_slow:
    v_mov_b32 v150, 0xff800000
    s_mov_b32 s52, 655360
L_slowloop_134:
    buffer_load_dwordx2 v[164:165], v5, s[32:35], s52 offen offset:2560 sc1
    buffer_load_dwordx4 v[152:155], v4, s[32:35], s52 offen sc1
    s_waitcnt vmcnt(0)
    v_mfma_f32_32x32x4_2b_bf16 v[192:223], v[164:165], v[24:25], 0 cbsz:1 abid:0
    s_nop 15
    s_nop 3
    v_mfma_f32_32x32x16_bf16 v[192:207], v[152:155], v[8:11], v[192:207]
    s_nop 15
    v_max3_f32 v150, v150, v192, v193
    v_max3_f32 v150, v150, v194, v195
    v_max3_f32 v150, v150, v196, v197
    v_max3_f32 v150, v150, v198, v199
    v_max3_f32 v150, v150, v200, v201
    v_max3_f32 v150, v150, v202, v203
    v_max3_f32 v150, v150, v204, v205
    v_max3_f32 v150, v150, v206, v207
    s_add_u32 s52, s52, 3072
    buffer_load_dwordx4 v[152:155], v4, s[32:35], s52 offen sc1
    s_waitcnt vmcnt(0)
    v_mfma_f32_32x32x4_2b_bf16 v[192:223], v[164:165], v[24:25], 0 cbsz:1 abid:1
    s_nop 15
    s_nop 3
    v_mfma_f32_32x32x16_bf16 v[192:207], v[152:155], v[8:11], v[192:207]
    s_nop 15
    v_max3_f32 v150, v150, v192, v193
    v_max3_f32 v150, v150, v194, v195
    v_max3_f32 v150, v150, v196, v197
    v_max3_f32 v150, v150, v198, v199
    v_max3_f32 v150, v150, v200, v201
    v_max3_f32 v150, v150, v202, v203
    v_max3_f32 v150, v150, v204, v205
    v_max3_f32 v150, v150, v206, v207
    s_add_u32 s52, s52, 3072
    s_cmp_lt_u32 s52, 851968
    s_cbranch_scc1 L_slowloop_134
    v_mov_b32 v151, v150
    s_nop 1
    v_permlane32_swap_b32 v150, v151
    v_max_f32 v150, v150, v151
    v_mov_b32 v64, 0
    v_mov_b32 v65, 0
    v_mov_b32 v66, 0
    v_mov_b32 v67, 0
    v_mov_b32 v68, 0
    v_mov_b32 v69, 0
    v_mov_b32 v70, 0
    v_mov_b32 v71, 0
    v_mov_b32 v72, 0
    v_mov_b32 v73, 0
    v_mov_b32 v74, 0
    v_mov_b32 v75, 0
    v_mov_b32 v76, 0
    v_mov_b32 v77, 0
    v_mov_b32 v78, 0
    v_mov_b32 v79, 0
    s_mov_b32 s52, 655360
L_slowloop_135:
    buffer_load_dwordx2 v[164:165], v5, s[32:35], s52 offen offset:2560 sc1
    buffer_load_dwordx4 v[152:155], v4, s[32:35], s52 offen sc1
    buffer_load_dwordx4 v[156:159], v6, s[32:35], s52 offen offset:1024 sc1
    buffer_load_dwordx4 v[160:163], v6, s[32:35], s52 offen offset:1792 sc1
    s_waitcnt vmcnt(0)
    v_mfma_f32_32x32x4_2b_bf16 v[192:223], v[164:165], v[24:25], 0 cbsz:1 abid:0
    s_nop 15
    s_nop 3
    v_mfma_f32_32x32x16_bf16 v[192:207], v[152:155], v[8:11], v[192:207]
    s_nop 15
    v_sub_f32 v192, v192, v150
    v_sub_f32 v193, v193, v150
    v_sub_f32 v194, v194, v150
    v_sub_f32 v195, v195, v150
    v_sub_f32 v196, v196, v150
    v_sub_f32 v197, v197, v150
    v_sub_f32 v198, v198, v150
    v_sub_f32 v199, v199, v150
    v_sub_f32 v200, v200, v150
    v_sub_f32 v201, v201, v150
    v_sub_f32 v202, v202, v150
    v_sub_f32 v203, v203, v150
    v_sub_f32 v204, v204, v150
    v_sub_f32 v205, v205, v150
    v_sub_f32 v206, v206, v150
    v_sub_f32 v207, v207, v150
    v_exp_f32 v192, v192
    v_exp_f32 v193, v193
    v_exp_f32 v194, v194
    v_exp_f32 v195, v195
    v_exp_f32 v196, v196
    v_exp_f32 v197, v197
    v_exp_f32 v198, v198
    v_exp_f32 v199, v199
    v_exp_f32 v200, v200
    v_exp_f32 v201, v201
    v_exp_f32 v202, v202
    v_exp_f32 v203, v203
    v_exp_f32 v204, v204
    v_exp_f32 v205, v205
    v_exp_f32 v206, v206
    v_exp_f32 v207, v207
    s_nop 2
    v_smfmac_f32_32x32x32_bf16 v[64:79], v[156:159], v[192:199], v7
    v_smfmac_f32_32x32x32_bf16 v[64:79], v[160:163], v[200:207], v7
    s_nop 15
    s_add_u32 s52, s52, 3072
    buffer_load_dwordx4 v[152:155], v4, s[32:35], s52 offen sc1
    buffer_load_dwordx4 v[156:159], v6, s[32:35], s52 offen offset:1024 sc1
    buffer_load_dwordx4 v[160:163], v6, s[32:35], s52 offen offset:1792 sc1
    s_waitcnt vmcnt(0)
    v_mfma_f32_32x32x4_2b_bf16 v[192:223], v[164:165], v[24:25], 0 cbsz:1 abid:1
    s_nop 15
    s_nop 3
    v_mfma_f32_32x32x16_bf16 v[192:207], v[152:155], v[8:11], v[192:207]
    s_nop 15
    v_sub_f32 v192, v192, v150
    v_sub_f32 v193, v193, v150
    v_sub_f32 v194, v194, v150
    v_sub_f32 v195, v195, v150
    v_sub_f32 v196, v196, v150
    v_sub_f32 v197, v197, v150
    v_sub_f32 v198, v198, v150
    v_sub_f32 v199, v199, v150
    v_sub_f32 v200, v200, v150
    v_sub_f32 v201, v201, v150
    v_sub_f32 v202, v202, v150
    v_sub_f32 v203, v203, v150
    v_sub_f32 v204, v204, v150
    v_sub_f32 v205, v205, v150
    v_sub_f32 v206, v206, v150
    v_sub_f32 v207, v207, v150
    v_exp_f32 v192, v192
    v_exp_f32 v193, v193
    v_exp_f32 v194, v194
    v_exp_f32 v195, v195
    v_exp_f32 v196, v196
    v_exp_f32 v197, v197
    v_exp_f32 v198, v198
    v_exp_f32 v199, v199
    v_exp_f32 v200, v200
    v_exp_f32 v201, v201
    v_exp_f32 v202, v202
    v_exp_f32 v203, v203
    v_exp_f32 v204, v204
    v_exp_f32 v205, v205
    v_exp_f32 v206, v206
    v_exp_f32 v207, v207
    s_nop 2
    v_smfmac_f32_32x32x32_bf16 v[64:79], v[156:159], v[192:199], v7
    v_smfmac_f32_32x32x32_bf16 v[64:79], v[160:163], v[200:207], v7
    s_nop 15
    s_add_u32 s52, s52, 3072
    s_cmp_lt_u32 s52, 851968
    s_cbranch_scc1 L_slowloop_135
    s_waitcnt lgkmcnt(0)
    ds_read_b64_tr_b16 v[128:129], v56 offset:0
    ds_read_b64_tr_b16 v[130:131], v56 offset:1280
    ds_read_b64_tr_b16 v[132:133], v56 offset:8
    ds_read_b64_tr_b16 v[134:135], v56 offset:1288
    ds_read_b64_tr_b16 v[136:137], v56 offset:16
    ds_read_b64_tr_b16 v[138:139], v56 offset:1296
    ds_read_b64_tr_b16 v[140:141], v56 offset:24
    ds_read_b64_tr_b16 v[142:143], v56 offset:1304
    ds_read_b64_tr_b16 v[144:145], v56 offset:32
    ds_read_b64_tr_b16 v[146:147], v56 offset:1312
    ds_read_b64_tr_b16 v[148:149], v56 offset:6400
    ds_read_b64_tr_b16 v[150:151], v56 offset:7680
    ds_read_b64_tr_b16 v[152:153], v56 offset:6408
    ds_read_b64_tr_b16 v[154:155], v56 offset:7688
    ds_read_b64_tr_b16 v[156:157], v56 offset:6416
    s_waitcnt lgkmcnt(13)
    ds_read_b64_tr_b16 v[158:159], v56 offset:7696
    ds_read_b64_tr_b16 v[160:161], v56 offset:6424
    s_waitcnt lgkmcnt(13)
    ds_read_b64_tr_b16 v[162:163], v56 offset:7704
    ds_read_b64_tr_b16 v[164:165], v56 offset:6432
    s_waitcnt lgkmcnt(13)
    ds_read_b64_tr_b16 v[166:167], v56 offset:7712
    ds_read_b64_tr_b16 v[192:193], v57 offset:0
    s_waitcnt lgkmcnt(13)
    ds_read_b64_tr_b16 v[194:195], v58 offset:0
    ds_read_b64_tr_b16 v[196:197], v57 offset:8
    s_waitcnt lgkmcnt(13)
    ds_read_b64_tr_b16 v[198:199], v58 offset:8
    ds_read_b64_tr_b16 v[200:201], v57 offset:16
    s_waitcnt lgkmcnt(13)
    ds_read_b64_tr_b16 v[202:203], v58 offset:16
    ds_read_b64_tr_b16 v[204:205], v57 offset:24
    s_waitcnt lgkmcnt(13)
    ds_read_b64_tr_b16 v[206:207], v58 offset:24
    ds_read_b64_tr_b16 v[208:209], v57 offset:32
    s_waitcnt lgkmcnt(13)
    ds_read_b64_tr_b16 v[210:211], v58 offset:32
    ds_read_b64_tr_b16 v[212:213], v56 offset:16000
    s_waitcnt lgkmcnt(13)
    ds_read_b64_tr_b16 v[214:215], v56 offset:17280
    ds_read_b64_tr_b16 v[216:217], v56 offset:16008
    s_waitcnt lgkmcnt(13)
    ds_read_b64_tr_b16 v[218:219], v56 offset:17288
    ds_read_b64_tr_b16 v[220:221], v56 offset:16016
    s_waitcnt lgkmcnt(13)
    ds_read_b64_tr_b16 v[222:223], v56 offset:17296
    ds_read_b64_tr_b16 v[224:225], v56 offset:16024
    s_waitcnt lgkmcnt(13)
    ds_read_b64_tr_b16 v[226:227], v56 offset:17304
    ds_read_b64_tr_b16 v[228:229], v56 offset:16032
    s_waitcnt lgkmcnt(13)
    ds_read_b64_tr_b16 v[230:231], v56 offset:17312
    ds_read_b64_tr_b16 v[232:233], v59 offset:0
    s_waitcnt lgkmcnt(13)
    ds_read_b64_tr_b16 v[234:235], v60 offset:0
    ds_read_b64_tr_b16 v[236:237], v59 offset:8
    s_waitcnt lgkmcnt(13)
    ds_read_b64_tr_b16 v[238:239], v60 offset:8
    ds_read_b64_tr_b16 v[240:241], v59 offset:16
    s_waitcnt lgkmcnt(13)
    ds_read_b64_tr_b16 v[242:243], v60 offset:16
    ds_read_b64_tr_b16 v[244:245], v59 offset:24
    s_waitcnt lgkmcnt(13)
    ds_read_b64_tr_b16 v[246:247], v60 offset:24
    ds_read_b64_tr_b16 v[248:249], v59 offset:32
    s_waitcnt lgkmcnt(13)
    ds_read_b64_tr_b16 v[250:251], v60 offset:32
    s_waitcnt lgkmcnt(0)
    v_rcp_f32 v74, v74
    s_branch L_slow_done
L_end:
    s_endpgm
.section .rodata,"a"
.p2align 6
.amdhsa_kernel adaLN_cond__grouped_kv_mqa__moe_arch_mod__prompt_kernel
  .amdhsa_next_free_vgpr 256
  .amdhsa_next_free_sgpr 102
  .amdhsa_accum_offset 256
  .amdhsa_group_segment_fixed_size 0
  .amdhsa_kernarg_size 120
  .amdhsa_user_sgpr_count 2
  .amdhsa_user_sgpr_kernarg_segment_ptr 1
  .amdhsa_system_sgpr_workgroup_id_x 1
.end_amdhsa_kernel
```
